```python
import torch

def _softmax(x, axis=-1):
    return torch.softmax(x, dim=axis)
def _gelu(x):
    return torch.nn.functional.gelu(x, approximate="tanh")
def _silu(x):
    return torch.nn.functional.silu(x)
def _sigmoid(x):
    return torch.sigmoid(x)
def _layernorm(x, axis=-1, eps=1e-5):
    m = x.mean(dim=axis, keepdim=True)
    v = x.var(dim=axis, keepdim=True, unbiased=False)
    return (x - m) / torch.sqrt(v + eps)
def _scatter_add(tgt, idx, src, axis=0):
    return tgt.clone().index_add_(axis, idx, src)
def _segment_sum(src, seg, n):
    out = torch.zeros((n,) + src.shape[1:], dtype=src.dtype)
    return out.index_add_(0, seg, src)
def _pad(x, pw):
    flat = tuple(v for pair in reversed(pw) for v in pair)
    return torch.nn.functional.pad(x, flat)

kernel_name = 'concat_heads__ssm_conv_h3__grouped_kv_mqa__prompt'

def setup_inputs():

    _w = (lambda a: (lambda t: t.to(torch.bfloat16) if t.is_floating_point() else t)(torch.as_tensor(a)))
    def _A_setup():
        B, S, D = 1, 2048, 640
        ks = 4
        return {
            "q": _w((lambda *s: torch.randn(*s, dtype=torch.bfloat16) * 0.05)(B, S, D)),
            "k": _w((lambda *s: torch.randn(*s, dtype=torch.bfloat16) * 0.4)(B, S, D)),
            "v": _w((lambda *s: torch.randn(*s, dtype=torch.bfloat16) * 0.2)(B, S, D)),
            "shift_k": _w((lambda *s: torch.randn(*s, dtype=torch.bfloat16) * 0.4)(D, ks) * 0.5),
            "ssm_k": _w((lambda *s: torch.randn(*s, dtype=torch.bfloat16) * 0.4)(D, S) * (1.0 / S ** 0.5)),
            "ssm_D": _w((lambda *s: torch.randn(*s, dtype=torch.bfloat16) * 0.2)(D)),
        }
    _A_in = _A_setup()

    def _B_setup():
        B, S, D, H = 1, 2048, 640, 32
        Dh = D // H
        return {
            "x": _w((lambda *s: torch.randn(*s, dtype=torch.bfloat16) * 0.05)(B, S, D)),
            "wq": _w((lambda *s: torch.randn(*s, dtype=torch.bfloat16) * 0.8)(D, H * Dh)),
            "wk": _w((lambda *s: torch.randn(*s, dtype=torch.bfloat16) * 0.8)(D, Dh)),
            "wv": _w((lambda *s: torch.randn(*s, dtype=torch.bfloat16) * 0.05)(D, Dh)),
            "wo": _w((lambda *s: torch.randn(*s, dtype=torch.bfloat16) * 0.05)(H * Dh, D)),
        }
    _B_in = _B_setup()

    return {
        "A_q": _A_in["q"],
        "A_k": _A_in["k"],
        "A_v": _A_in["v"],
        "A_shift_k": _A_in["shift_k"],
        "A_ssm_k": _A_in["ssm_k"],
        "A_ssm_D": _A_in["ssm_D"],
        "B_x": _B_in["x"],
        "B_wq": _B_in["wq"],
        "B_wk": _B_in["wk"],
        "B_wv": _B_in["wv"],
        "B_wo": _B_in["wo"],
    }

def reference(A_q, A_k, A_v, A_shift_k, A_ssm_k, A_ssm_D, B_x, B_wq, B_wk, B_wv, B_wo):
    def _A_ref(q, k, v, shift_k, ssm_k, ssm_D):
        B, S, D = q.shape
        ks = shift_k.shape[-1]
        k_pad = _pad(k, ((0, 0), (ks - 1, 0), (0, 0)))
        k_shift = torch.zeros_like(k)
        for t in range(ks):
            k_shift = k_shift + k_pad[:, t:t + S, :] * shift_k[:, ks - 1 - t][None, None, :]
        kv = k_shift * v
        L = 2 * S
        kv_pad = _pad(kv, ((0, 0), (0, S), (0, 0)))
        kf_pad = _pad(ssm_k, ((0, 0), (0, S)))
        kv_f = (lambda x, axes=(-2,-1): torch.fft.rfft2(x.float(), dim=axes))(kv_pad[:, None, :, :], axes=(1, 2))
        kf_f = (lambda x, axes=(-2,-1): torch.fft.rfft2(x.float(), dim=axes))(kf_pad[:, None, :], axes=(1, 2))
        kf_f = (lambda x, *d: x.permute(*d))(kf_f, 1, 2, 0)
        y_f = kv_f * kf_f[None, :, :, :]
        y = (lambda x, s, axes=(-2,-1): torch.fft.irfft2(x, s=s, dim=axes).to(torch.bfloat16))(y_f, (1, L), axes=(1, 2))[:, 0, :S, :]
        y = y + kv * ssm_D[None, None, :]
        return q * y

    def _B_ref(x, wq, wk, wv, wo):
        B, S, D = x.shape
        H = 32
        Dh = D // H
        q = (lambda x, *d: x.permute(*d))((x @ wq).reshape(B, S, H, Dh), 0, 2, 1, 3)
        k = x @ wk
        v = x @ wv
        scores = torch.einsum("bhqd,bkd->bhqk", q, k) * (Dh ** -0.5)
        p = _softmax(scores, axis=-1)
        o = torch.einsum("bhqk,bkd->bhqd", p, v)
        return (lambda x, *d: x.permute(*d))(o, 0, 2, 1, 3).reshape(B, S, H * Dh) @ wo

    a = _A_ref(A_q, A_k, A_v, A_shift_k, A_ssm_k, A_ssm_D)
    b = _B_ref(B_x, B_wq, B_wk, B_wv, B_wo)
    return torch.concatenate([a, b], axis=-1)
```

```asm
; @launch grid=(256,1,1) block=(512,1,1) lds=163840
.amdgcn_target "amdgcn-amd-amdhsa--gfx950"
.text
.globl concat_heads__ssm_conv_h3__grouped_kv_mqa__prompt_kernel
.p2align 8
.type concat_heads__ssm_conv_h3__grouped_kv_mqa__prompt_kernel,@function
concat_heads__ssm_conv_h3__grouped_kv_mqa__prompt_kernel:
    s_cmp_ge_u32 s2, 256
    s_cbranch_scc1 L_exit
    s_load_dwordx16 s[16:31], s[0:1], 0
    s_load_dwordx8 s[32:39], s[0:1], 64
    s_load_dwordx4 s[40:43], s[0:1], 96
    v_lshrrev_b32 v1, 6, v0
    s_and_b32 s7, s2, 7
    s_lshl_b32 s3, s7, 2
    s_lshr_b32 s4, s2, 3
    v_readfirstlane_b32 s5, v1
    s_and_b32 s6, s4, 3
    s_add_u32 s3, s3, s6
    s_lshr_b32 s4, s4, 2
    v_and_b32 v1, 63, v0
    v_and_b32 v2, 15, v1
    v_lshrrev_b32 v3, 4, v1
    s_mul_i32 s64, s3, 81920
    s_mul_i32 s65, s4, 160
    s_add_u32 s66, s6, s7
    s_mul_i32 s8, s66, 52
    s_lshr_b32 s8, s8, 8
    s_mul_i32 s8, s8, 5
    s_sub_u32 s66, s66, s8
    s_and_b32 s67, s4, 3
    s_cmp_ge_u32 s5, 4
    s_cbranch_scc1 L_1
    v_lshrrev_b32 v4, 3, v1
    v_mul_u32_u24 v4, 1280, v4
    v_and_b32 v5, 7, v1
    v_xor_b32 v5, v5, v3
    v_lshl_add_u32 v28, v5, 4, v4
    v_xor_b32 v29, 64, v28
    s_add_u32 s8, s67, s5
    s_and_b32 s8, s8, 3
    s_mul_i32 s10, s8, 20480
    s_add_u32 s10, s10, s64
    s_lshl_b32 s11, s8, 11
    s_lshl_b32 s12, s66, 8
    s_mul_i32 s13, s66, 5120
    v_lshlrev_b32 v45, 5, v1
    s_and_b32 s76, s5, 1
    s_lshr_b32 s77, s5, 1
    v_lshlrev_b32 v62, 4, v1
    v_bfe_u32 v192, v1, 4, 1
    v_mul_u32_u24 v192, 20480, v192
    v_lshl_add_u32 v59, v2, 3, v192
    v_lshl_add_u32 v192, v2, 4, v192
    v_lshrrev_b32 v193, 5, v1
    v_lshl_add_u32 v58, v193, 8, v192
    s_lshl_b32 s8, s3, 2
    s_lshl_b32 s9, s76, 1
    s_add_u32 s8, s8, s9
    s_mul_i32 s8, s8, 20480
    s_add_u32 s8, s8, 262144
    s_lshl_b32 s9, s4, 2
    s_add_u32 s9, s9, s77
    s_lshl_b32 s72, s9, 9
    s_add_u32 s72, s72, s8
    s_lshl_b32 s73, s9, 7
    s_add_u32 s73, s73, s8
    s_add_u32 s73, s73, 16384
    s_lshl_b32 s74, s3, 1
    s_add_u32 s74, s74, s76
    s_lshl_b32 s74, s74, 5
    s_add_u32 s74, s74, s9
    s_lshl_b32 s74, s74, 2
    s_add_u32 s74, s74, 16384
    s_xor_b32 s8, s5, 4
    s_and_b32 s8, s8, 3
    s_mul_i32 s8, s8, 9216
    s_add_u32 s8, s8, 116992
    v_add_u32 v56, s8, v62
    s_xor_b32 s8, s5, 6
    s_and_b32 s8, s8, 3
    s_mul_i32 s8, s8, 9216
    s_add_u32 s8, s8, 120064
    v_add_u32 v57, s8, v62
    v_mov_b32 v44, 113664
    s_and_b32 s6, s77, 1
    v_lshrrev_b32 v4, 1, v2
    v_xor_b32 v4, v4, v3
    v_lshlrev_b32 v5, 7, v2
    v_lshl_add_u32 v39, v4, 4, v5
    s_lshl_b32 s7, s76, 1
    s_add_u32 s7, s7, s6
    s_lshl_b32 s8, s7, 11
    s_lshl_b32 s9, s6, 6
    v_xor_b32 v4, s9, v39
    v_add_u32 v34, s8, v4
    v_xor_b32 v35, 0x800, v34
    v_bfe_u32 v4, v1, 2, 2
    v_lshl_add_u32 v4, v3, 3, v4
    v_and_b32 v5, 1, v3
    v_lshl_add_u32 v6, v5, 2, v4
    v_xor_b32 v7, 4, v6
    v_and_b32 v5, 3, v1
    v_lshlrev_b32 v5, 3, v5
    s_movk_i32 s9, 160
    v_mad_u32_u24 v6, v6, s9, v5
    v_mad_u32_u24 v7, v7, s9, v5
    s_mul_i32 s8, s6, 5120
    s_add_u32 s8, s8, 81920
    v_add_u32 v36, s8, v6
    v_add_u32 v37, s8, v7
    s_mul_i32 s8, s76, 51200
    v_add_u32 v52, s8, v6
    v_add_u32 v53, s8, v7
    s_mul_i32 s8, s7, 2816
    s_add_u32 s8, s8, 102400
    v_mul_u32_u24 v4, 176, v2
    v_lshl_add_u32 v4, v3, 3, v4
    v_add_u32 v38, s8, v4
    s_mul_i32 s8, s5, 3072
    s_add_u32 s8, s8, 32768
    v_add_u32 v46, s8, v62
    s_xor_b32 s8, s5, 2
    s_mul_i32 s8, s8, 3072
    s_add_u32 s8, s8, 32768
    v_add_u32 v47, s8, v62
    v_mul_u32_u24 v54, 336, v2
    v_lshl_add_u32 v54, v3, 4, v54
    s_mul_i32 s8, s77, 5376
    s_mul_i32 s9, s76, 21504
    s_add_u32 s8, s8, s9
    s_add_u32 s8, s8, 102400
    v_add_u32 v54, s8, v54
    s_cmp_lg_u32 s5, 0
    s_cbranch_scc1 L_3
    v_add_u32 v40, s11, v39
    v_xor_b32 v41, 64, v40
    v_bfe_u32 v4, v1, 2, 2
    v_lshl_add_u32 v4, v3, 3, v4
    v_mul_u32_u24 v4, 40, v4
    v_add_u32 v42, 138240, v4
    v_and_b32 v5, 3, v1
    v_lshl_add_u32 v43, v5, 3, v42
    v_mov_b32 v244, -1
    v_mov_b32 v245, -1
    v_mov_b32 v246, -1
    v_mov_b32 v247, -1
    v_mov_b32 v248, -1
    v_mov_b32 v224, -1
    v_mov_b32 v225, -1
    v_mov_b32 v226, -1
    v_mov_b32 v227, -1
    v_mov_b32 v228, -1
    v_mov_b32 v229, -1
    v_mov_b32 v230, -1
    v_mov_b32 v231, -1
    v_mov_b32 v232, -1
    v_mov_b32 v233, -1
    s_waitcnt lgkmcnt(0)
    s_load_dword s78, s[42:43], 0
    s_cmp_ge_u32 s4, 4
    s_cselect_b32 s56, s34, s32
    s_cselect_b32 s57, s35, s33
    s_mov_b32 s58, 25600
    s_mov_b32 s59, 0x20000
    s_mov_b32 s48, s28
    s_mov_b32 s49, s29
    s_mov_b32 s50, 2621440
    s_mov_b32 s51, 0x20000
    s_mov_b32 m0, 138240
    s_nop 0
    buffer_load_dwordx4 v62, s[56:59], s13 offen offset:0 lds
    buffer_load_dwordx4 v62, s[56:59], s13 offen offset:1024 lds
    buffer_load_dwordx4 v62, s[56:59], s13 offen offset:2048 lds
    buffer_load_dwordx4 v62, s[56:59], s13 offen offset:3072 lds
    s_mov_b32 m0, 142336
    s_add_u32 s8, s13, 4096
    buffer_load_dwordx4 v62, s[56:59], s8 offen lds
    s_add_u32 s13, s13, 5120
    s_cmp_ge_u32 s13, 25600
    s_cselect_b32 s13, 0, s13
    s_mov_b32 m0, 143360
    s_nop 0
    buffer_load_dwordx4 v62, s[56:59], s13 offen offset:0 lds
    buffer_load_dwordx4 v62, s[56:59], s13 offen offset:1024 lds
    buffer_load_dwordx4 v62, s[56:59], s13 offen offset:2048 lds
    buffer_load_dwordx4 v62, s[56:59], s13 offen offset:3072 lds
    s_mov_b32 m0, 147456
    s_add_u32 s8, s13, 4096
    buffer_load_dwordx4 v62, s[56:59], s8 offen lds
    s_add_u32 s13, s13, 5120
    s_cmp_ge_u32 s13, 25600
    s_cselect_b32 s13, 0, s13
    s_mov_b32 m0, 148480
    s_nop 0
    buffer_load_dwordx4 v62, s[56:59], s13 offen offset:0 lds
    buffer_load_dwordx4 v62, s[56:59], s13 offen offset:1024 lds
    buffer_load_dwordx4 v62, s[56:59], s13 offen offset:2048 lds
    buffer_load_dwordx4 v62, s[56:59], s13 offen offset:3072 lds
    s_mov_b32 m0, 152576
    s_add_u32 s8, s13, 4096
    buffer_load_dwordx4 v62, s[56:59], s8 offen lds
    s_add_u32 s13, s13, 5120
    s_cmp_ge_u32 s13, 25600
    s_cselect_b32 s13, 0, s13
    s_mov_b32 m0, 153600
    s_nop 0
    buffer_load_dwordx4 v62, s[56:59], s13 offen offset:0 lds
    buffer_load_dwordx4 v62, s[56:59], s13 offen offset:1024 lds
    buffer_load_dwordx4 v62, s[56:59], s13 offen offset:2048 lds
    buffer_load_dwordx4 v62, s[56:59], s13 offen offset:3072 lds
    s_mov_b32 m0, 157696
    s_add_u32 s8, s13, 4096
    buffer_load_dwordx4 v62, s[56:59], s8 offen lds
    s_add_u32 s13, s13, 5120
    s_cmp_ge_u32 s13, 25600
    s_cselect_b32 s13, 0, s13
    s_mov_b32 m0, 158720
    s_nop 0
    buffer_load_dwordx4 v62, s[56:59], s13 offen offset:0 lds
    buffer_load_dwordx4 v62, s[56:59], s13 offen offset:1024 lds
    buffer_load_dwordx4 v62, s[56:59], s13 offen offset:2048 lds
    buffer_load_dwordx4 v62, s[56:59], s13 offen offset:3072 lds
    s_mov_b32 m0, 162816
    s_add_u32 s8, s13, 4096
    buffer_load_dwordx4 v62, s[56:59], s8 offen lds
    s_add_u32 s8, s10, s12
    s_add_u32 s9, s8, 10240
    s_add_u32 m0, s11, 0
    s_nop 0
    buffer_load_dwordx4 v28, s[48:51], s8 offen offset:0 lds
    s_add_u32 m0, s11, 1024
    s_nop 0
    buffer_load_dwordx4 v29, s[48:51], s9 offen offset:0 lds
    s_add_u32 m0, s11, 8064
    s_nop 0
    buffer_load_dwordx4 v28, s[48:51], s8 offen offset:128 lds
    s_add_u32 m0, s11, 9088
    s_nop 0
    buffer_load_dwordx4 v29, s[48:51], s9 offen offset:128 lds
    s_add_u32 s12, s12, 256
    s_cmp_ge_u32 s12, 1280
    s_cselect_b32 s12, 0, s12
    s_add_u32 s8, s10, s12
    s_add_u32 s9, s8, 10240
    s_add_u32 m0, s11, 16384
    s_nop 0
    buffer_load_dwordx4 v28, s[48:51], s8 offen offset:0 lds
    s_add_u32 m0, s11, 17408
    s_nop 0
    buffer_load_dwordx4 v29, s[48:51], s9 offen offset:0 lds
    s_add_u32 m0, s11, 24448
    s_nop 0
    buffer_load_dwordx4 v28, s[48:51], s8 offen offset:128 lds
    s_add_u32 m0, s11, 25472
    s_nop 0
    buffer_load_dwordx4 v29, s[48:51], s9 offen offset:128 lds
    s_add_u32 s12, s12, 256
    s_cmp_ge_u32 s12, 1280
    s_cselect_b32 s12, 0, s12
    s_add_u32 s8, s10, s12
    s_add_u32 s9, s8, 10240
    s_add_u32 m0, s11, 32768
    s_nop 0
    buffer_load_dwordx4 v28, s[48:51], s8 offen offset:0 lds
    s_add_u32 m0, s11, 33792
    s_nop 0
    buffer_load_dwordx4 v29, s[48:51], s9 offen offset:0 lds
    s_add_u32 m0, s11, 40832
    s_nop 0
    buffer_load_dwordx4 v28, s[48:51], s8 offen offset:128 lds
    s_add_u32 m0, s11, 41856
    s_nop 0
    buffer_load_dwordx4 v29, s[48:51], s9 offen offset:128 lds
    s_add_u32 s12, s12, 256
    s_cmp_ge_u32 s12, 1280
    s_cselect_b32 s12, 0, s12
    s_add_u32 s8, s10, s12
    s_add_u32 s9, s8, 10240
    s_add_u32 m0, s11, 49152
    s_nop 0
    buffer_load_dwordx4 v28, s[48:51], s8 offen offset:0 lds
    s_add_u32 m0, s11, 50176
    s_nop 0
    buffer_load_dwordx4 v29, s[48:51], s9 offen offset:0 lds
    s_add_u32 m0, s11, 57216
    s_nop 0
    buffer_load_dwordx4 v28, s[48:51], s8 offen offset:128 lds
    s_add_u32 m0, s11, 58240
    s_nop 0
    buffer_load_dwordx4 v29, s[48:51], s9 offen offset:128 lds
    s_add_u32 s12, s12, 256
    s_cmp_ge_u32 s12, 1280
    s_cselect_b32 s12, 0, s12
    s_add_u32 s8, s10, s12
    s_add_u32 s9, s8, 10240
    s_add_u32 m0, s11, 65536
    s_nop 0
    buffer_load_dwordx4 v28, s[48:51], s8 offen offset:0 lds
    s_add_u32 m0, s11, 66560
    s_nop 0
    buffer_load_dwordx4 v29, s[48:51], s9 offen offset:0 lds
    s_add_u32 m0, s11, 73600
    s_nop 0
    buffer_load_dwordx4 v28, s[48:51], s8 offen offset:128 lds
    s_add_u32 m0, s11, 74624
    s_nop 0
    buffer_load_dwordx4 v29, s[48:51], s9 offen offset:128 lds
    s_barrier
    s_mov_b32 s44, s42
    s_mov_b32 s45, s43
    s_mov_b32 s46, 10747904
    s_mov_b32 s47, 0x20000
    s_waitcnt lgkmcnt(0)
    s_mul_i32 s78, s78, 0x9E3779B1
    s_add_u32 s78, s78, 0x7F4A7C15
    s_waitcnt vmcnt(40)
    ds_read_b64_tr_b16 v[96:97], v43 offset:0
    ds_read_b64_tr_b16 v[98:99], v43 offset:160
    ds_read_b64_tr_b16 v[100:101], v42 offset:32
    ds_read_b64_tr_b16 v[102:103], v42 offset:192
    ds_read_b64_tr_b16 v[104:105], v43 offset:1280
    ds_read_b64_tr_b16 v[106:107], v43 offset:1440
    ds_read_b64_tr_b16 v[108:109], v42 offset:1312
    ds_read_b64_tr_b16 v[110:111], v42 offset:1472
    ds_read_b64_tr_b16 v[112:113], v43 offset:2560
    ds_read_b64_tr_b16 v[114:115], v43 offset:2720
    ds_read_b64_tr_b16 v[116:117], v42 offset:2592
    ds_read_b64_tr_b16 v[118:119], v42 offset:2752
    ds_read_b64_tr_b16 v[120:121], v43 offset:3840
    ds_read_b64_tr_b16 v[122:123], v43 offset:4000
    ds_read_b64_tr_b16 v[124:125], v42 offset:3872
    ds_read_b64_tr_b16 v[126:127], v42 offset:4032
    s_waitcnt vmcnt(35)
    ds_read_b64_tr_b16 v[128:129], v43 offset:5120
    ds_read_b64_tr_b16 v[130:131], v43 offset:5280
    ds_read_b64_tr_b16 v[132:133], v42 offset:5152
    ds_read_b64_tr_b16 v[134:135], v42 offset:5312
    ds_read_b64_tr_b16 v[136:137], v43 offset:6400
    ds_read_b64_tr_b16 v[138:139], v43 offset:6560
    ds_read_b64_tr_b16 v[140:141], v42 offset:6432
    ds_read_b64_tr_b16 v[142:143], v42 offset:6592
    ds_read_b64_tr_b16 v[144:145], v43 offset:7680
    ds_read_b64_tr_b16 v[146:147], v43 offset:7840
    ds_read_b64_tr_b16 v[148:149], v42 offset:7712
    ds_read_b64_tr_b16 v[150:151], v42 offset:7872
    ds_read_b64_tr_b16 v[152:153], v43 offset:8960
    ds_read_b64_tr_b16 v[154:155], v43 offset:9120
    ds_read_b64_tr_b16 v[156:157], v42 offset:8992
    ds_read_b64_tr_b16 v[158:159], v42 offset:9152
    s_waitcnt vmcnt(30)
    ds_read_b64_tr_b16 v[160:161], v43 offset:10240
    ds_read_b64_tr_b16 v[162:163], v43 offset:10400
    ds_read_b64_tr_b16 v[164:165], v42 offset:10272
    ds_read_b64_tr_b16 v[166:167], v42 offset:10432
    ds_read_b64_tr_b16 v[168:169], v43 offset:11520
    ds_read_b64_tr_b16 v[170:171], v43 offset:11680
    ds_read_b64_tr_b16 v[172:173], v42 offset:11552
    ds_read_b64_tr_b16 v[174:175], v42 offset:11712
    ds_read_b64_tr_b16 v[176:177], v43 offset:12800
    ds_read_b64_tr_b16 v[178:179], v43 offset:12960
    ds_read_b64_tr_b16 v[180:181], v42 offset:12832
    ds_read_b64_tr_b16 v[182:183], v42 offset:12992
    ds_read_b64_tr_b16 v[184:185], v43 offset:14080
    ds_read_b64_tr_b16 v[186:187], v43 offset:14240
    ds_read_b64_tr_b16 v[188:189], v42 offset:14112
    ds_read_b64_tr_b16 v[190:191], v42 offset:14272
    s_waitcnt vmcnt(25)
    ds_read_b64_tr_b16 v[192:193], v43 offset:15360
    ds_read_b64_tr_b16 v[194:195], v43 offset:15520
    ds_read_b64_tr_b16 v[196:197], v42 offset:15392
    ds_read_b64_tr_b16 v[198:199], v42 offset:15552
    ds_read_b64_tr_b16 v[200:201], v43 offset:16640
    ds_read_b64_tr_b16 v[202:203], v43 offset:16800
    ds_read_b64_tr_b16 v[204:205], v42 offset:16672
    ds_read_b64_tr_b16 v[206:207], v42 offset:16832
    ds_read_b64_tr_b16 v[208:209], v43 offset:17920
    ds_read_b64_tr_b16 v[210:211], v43 offset:18080
    ds_read_b64_tr_b16 v[212:213], v42 offset:17952
    ds_read_b64_tr_b16 v[214:215], v42 offset:18112
    ds_read_b64_tr_b16 v[216:217], v43 offset:19200
    ds_read_b64_tr_b16 v[218:219], v43 offset:19360
    ds_read_b64_tr_b16 v[220:221], v42 offset:19232
    ds_read_b64_tr_b16 v[222:223], v42 offset:19392
    s_waitcnt vmcnt(20)
    ds_read_b64_tr_b16 v[224:225], v43 offset:20480
    ds_read_b64_tr_b16 v[226:227], v43 offset:20640
    ds_read_b64_tr_b16 v[228:229], v42 offset:20512
    ds_read_b64_tr_b16 v[230:231], v42 offset:20672
    ds_read_b64_tr_b16 v[232:233], v43 offset:21760
    ds_read_b64_tr_b16 v[234:235], v43 offset:21920
    ds_read_b64_tr_b16 v[236:237], v42 offset:21792
    ds_read_b64_tr_b16 v[238:239], v42 offset:21952
    ds_read_b64_tr_b16 v[240:241], v43 offset:23040
    ds_read_b64_tr_b16 v[242:243], v43 offset:23200
    ds_read_b64_tr_b16 v[244:245], v42 offset:23072
    ds_read_b64_tr_b16 v[246:247], v42 offset:23232
    ds_read_b64_tr_b16 v[248:249], v43 offset:24320
    ds_read_b64_tr_b16 v[250:251], v43 offset:24480
    ds_read_b64_tr_b16 v[252:253], v42 offset:24352
    ds_read_b64_tr_b16 v[254:255], v42 offset:24512
    s_lshr_b32 s12, s67, 1
    s_lshl_b32 s14, s3, 1
    s_add_u32 s12, s12, s14
    s_mul_i32 s12, s12, 2816
    s_add_u32 s12, s12, 32768
    s_and_b32 s10, s67, 1
    s_cmp_ge_u32 s4, 4
    s_cbranch_scc1 L_5
    s_lshl_b32 s10, s10, 4
    v_add_u32 v5, s10, v2
    v_lshrrev_b32 v6, 1, v3
    v_lshl_add_u32 v6, v6, 5, v5
    v_lshlrev_b32 v6, 4, v6
    v_lshlrev_b32 v5, 3, v5
    s_waitcnt vmcnt(16)
    ds_read_b128 v[72:75], v40 offset:0
    ds_read_b128 v[76:79], v41 offset:0
    ds_read_b128 v[80:83], v40 offset:8192
    ds_read_b128 v[84:87], v41 offset:8192
    s_waitcnt lgkmcnt(3)
    v_mfma_f32_16x16x32_bf16 v[16:19], v[96:99], v[72:75], 0
    v_mfma_f32_16x16x32_bf16 v[20:23], v[100:103], v[72:75], 0
    s_waitcnt lgkmcnt(2)
    v_mfma_f32_16x16x32_bf16 v[16:19], v[104:107], v[76:79], v[16:19]
    v_mfma_f32_16x16x32_bf16 v[20:23], v[108:111], v[76:79], v[20:23]
    s_waitcnt lgkmcnt(1)
    v_mfma_f32_16x16x32_bf16 v[16:19], v[112:115], v[80:83], v[16:19]
    v_mfma_f32_16x16x32_bf16 v[20:23], v[116:119], v[80:83], v[20:23]
    s_waitcnt lgkmcnt(0)
    v_mfma_f32_16x16x32_bf16 v[16:19], v[120:123], v[84:87], v[16:19]
    v_mfma_f32_16x16x32_bf16 v[20:23], v[124:127], v[84:87], v[20:23]
    s_waitcnt vmcnt(12)
    ds_read_b128 v[72:75], v40 offset:16384
    ds_read_b128 v[76:79], v41 offset:16384
    ds_read_b128 v[80:83], v40 offset:24576
    ds_read_b128 v[84:87], v41 offset:24576
    s_waitcnt lgkmcnt(3)
    v_mfma_f32_16x16x32_bf16 v[16:19], v[128:131], v[72:75], v[16:19]
    v_mfma_f32_16x16x32_bf16 v[20:23], v[132:135], v[72:75], v[20:23]
    s_waitcnt lgkmcnt(2)
    v_mfma_f32_16x16x32_bf16 v[16:19], v[136:139], v[76:79], v[16:19]
    v_mfma_f32_16x16x32_bf16 v[20:23], v[140:143], v[76:79], v[20:23]
    s_waitcnt lgkmcnt(1)
    v_mfma_f32_16x16x32_bf16 v[16:19], v[144:147], v[80:83], v[16:19]
    v_mfma_f32_16x16x32_bf16 v[20:23], v[148:151], v[80:83], v[20:23]
    s_waitcnt lgkmcnt(0)
    v_mfma_f32_16x16x32_bf16 v[16:19], v[152:155], v[84:87], v[16:19]
    v_mfma_f32_16x16x32_bf16 v[20:23], v[156:159], v[84:87], v[20:23]
    s_waitcnt vmcnt(8)
    ds_read_b128 v[72:75], v40 offset:32768
    ds_read_b128 v[76:79], v41 offset:32768
    ds_read_b128 v[80:83], v40 offset:40960
    ds_read_b128 v[84:87], v41 offset:40960
    s_waitcnt lgkmcnt(3)
    v_mfma_f32_16x16x32_bf16 v[16:19], v[160:163], v[72:75], v[16:19]
    v_mfma_f32_16x16x32_bf16 v[20:23], v[164:167], v[72:75], v[20:23]
    s_waitcnt lgkmcnt(2)
    v_mfma_f32_16x16x32_bf16 v[16:19], v[168:171], v[76:79], v[16:19]
    v_mfma_f32_16x16x32_bf16 v[20:23], v[172:175], v[76:79], v[20:23]
    s_waitcnt lgkmcnt(1)
    v_mfma_f32_16x16x32_bf16 v[16:19], v[176:179], v[80:83], v[16:19]
    v_mfma_f32_16x16x32_bf16 v[20:23], v[180:183], v[80:83], v[20:23]
    s_waitcnt lgkmcnt(0)
    v_mfma_f32_16x16x32_bf16 v[16:19], v[184:187], v[84:87], v[16:19]
    v_mfma_f32_16x16x32_bf16 v[20:23], v[188:191], v[84:87], v[20:23]
    s_waitcnt vmcnt(4)
    ds_read_b128 v[72:75], v40 offset:49152
    ds_read_b128 v[76:79], v41 offset:49152
    ds_read_b128 v[80:83], v40 offset:57344
    ds_read_b128 v[84:87], v41 offset:57344
    s_waitcnt lgkmcnt(3)
    v_mfma_f32_16x16x32_bf16 v[16:19], v[192:195], v[72:75], v[16:19]
    v_mfma_f32_16x16x32_bf16 v[20:23], v[196:199], v[72:75], v[20:23]
    s_waitcnt lgkmcnt(2)
    v_mfma_f32_16x16x32_bf16 v[16:19], v[200:203], v[76:79], v[16:19]
    v_mfma_f32_16x16x32_bf16 v[20:23], v[204:207], v[76:79], v[20:23]
    s_waitcnt lgkmcnt(1)
    v_mfma_f32_16x16x32_bf16 v[16:19], v[208:211], v[80:83], v[16:19]
    v_mfma_f32_16x16x32_bf16 v[20:23], v[212:215], v[80:83], v[20:23]
    s_waitcnt lgkmcnt(0)
    v_mfma_f32_16x16x32_bf16 v[16:19], v[216:219], v[84:87], v[16:19]
    v_mfma_f32_16x16x32_bf16 v[20:23], v[220:223], v[84:87], v[20:23]
    v_add_u32 v40, 65536, v40
    v_add_u32 v41, 65536, v41
    s_waitcnt vmcnt(0)
    ds_read_b128 v[72:75], v40 offset:0
    ds_read_b128 v[76:79], v41 offset:0
    ds_read_b128 v[80:83], v40 offset:8192
    ds_read_b128 v[84:87], v41 offset:8192
    s_waitcnt lgkmcnt(3)
    v_mfma_f32_16x16x32_bf16 v[16:19], v[224:227], v[72:75], v[16:19]
    v_mfma_f32_16x16x32_bf16 v[20:23], v[228:231], v[72:75], v[20:23]
    s_waitcnt lgkmcnt(2)
    v_mfma_f32_16x16x32_bf16 v[16:19], v[232:235], v[76:79], v[16:19]
    v_mfma_f32_16x16x32_bf16 v[20:23], v[236:239], v[76:79], v[20:23]
    s_waitcnt lgkmcnt(1)
    v_mfma_f32_16x16x32_bf16 v[16:19], v[240:243], v[80:83], v[16:19]
    v_mfma_f32_16x16x32_bf16 v[20:23], v[244:247], v[80:83], v[20:23]
    s_waitcnt lgkmcnt(0)
    v_mfma_f32_16x16x32_bf16 v[16:19], v[248:251], v[84:87], v[16:19]
    v_mfma_f32_16x16x32_bf16 v[20:23], v[252:255], v[84:87], v[20:23]
    s_nop 6
    v_cvt_pk_bf16_f32 v64, v16, v17
    v_cvt_pk_bf16_f32 v65, v18, v19
    v_cvt_pk_bf16_f32 v66, v16, v17
    v_cvt_pk_bf16_f32 v67, v18, v19
    s_nop 0
    v_permlane16_swap_b32 v64, v66
    v_permlane16_swap_b32 v65, v67
    v_cvt_pk_bf16_f32 v68, v20, v21
    v_cvt_pk_bf16_f32 v69, v22, v23
    s_mov_b32 exec_lo, 0xffff
    s_mov_b32 exec_hi, 0xffff
    buffer_store_dwordx4 v[64:67], v6, s[44:47], s12 offen offset:256 sc1
    s_mov_b64 exec, 0xffff
    buffer_store_dwordx2 v[68:69], v5, s[44:47], s12 offen offset:0 sc1
    s_mov_b64 exec, -1
    s_branch L_6
L_5:
    s_mul_i32 s10, s10, 768
    s_add_u32 s12, s12, s10
    v_and_b32 v5, 1, v3
    v_mul_u32_u24 v5, 20, v5
    v_add_u32 v6, v5, v2
    v_lshlrev_b32 v6, 4, v6
    v_cmp_lt_u32 s[14:15], 3, v2
    v_mov_b32 v10, 0x3f803f80
    s_waitcnt vmcnt(16)
    ds_read_b128 v[72:75], v40 offset:0
    ds_read_b128 v[76:79], v41 offset:0
    ds_read_b128 v[80:83], v40 offset:8192
    ds_read_b128 v[84:87], v41 offset:8192
    s_waitcnt lgkmcnt(3)
    v_mfma_f32_16x16x32_bf16 v[16:19], v[72:75], v[96:99], 0
    v_mfma_f32_16x16x32_bf16 v[20:23], v[72:75], v[100:103], 0
    s_waitcnt lgkmcnt(2)
    v_mfma_f32_16x16x32_bf16 v[16:19], v[76:79], v[104:107], v[16:19]
    v_mfma_f32_16x16x32_bf16 v[20:23], v[76:79], v[108:111], v[20:23]
    s_waitcnt lgkmcnt(1)
    v_mfma_f32_16x16x32_bf16 v[16:19], v[80:83], v[112:115], v[16:19]
    v_mfma_f32_16x16x32_bf16 v[20:23], v[80:83], v[116:119], v[20:23]
    s_waitcnt lgkmcnt(0)
    v_mfma_f32_16x16x32_bf16 v[16:19], v[84:87], v[120:123], v[16:19]
    v_mfma_f32_16x16x32_bf16 v[20:23], v[84:87], v[124:127], v[20:23]
    s_waitcnt vmcnt(12)
    ds_read_b128 v[72:75], v40 offset:16384
    ds_read_b128 v[76:79], v41 offset:16384
    ds_read_b128 v[80:83], v40 offset:24576
    ds_read_b128 v[84:87], v41 offset:24576
    s_waitcnt lgkmcnt(3)
    v_mfma_f32_16x16x32_bf16 v[16:19], v[72:75], v[128:131], v[16:19]
    v_mfma_f32_16x16x32_bf16 v[20:23], v[72:75], v[132:135], v[20:23]
    s_waitcnt lgkmcnt(2)
    v_mfma_f32_16x16x32_bf16 v[16:19], v[76:79], v[136:139], v[16:19]
    v_mfma_f32_16x16x32_bf16 v[20:23], v[76:79], v[140:143], v[20:23]
    s_waitcnt lgkmcnt(1)
    v_mfma_f32_16x16x32_bf16 v[16:19], v[80:83], v[144:147], v[16:19]
    v_mfma_f32_16x16x32_bf16 v[20:23], v[80:83], v[148:151], v[20:23]
    s_waitcnt lgkmcnt(0)
    v_mfma_f32_16x16x32_bf16 v[16:19], v[84:87], v[152:155], v[16:19]
    v_mfma_f32_16x16x32_bf16 v[20:23], v[84:87], v[156:159], v[20:23]
    s_waitcnt vmcnt(8)
    ds_read_b128 v[72:75], v40 offset:32768
    ds_read_b128 v[76:79], v41 offset:32768
    ds_read_b128 v[80:83], v40 offset:40960
    ds_read_b128 v[84:87], v41 offset:40960
    s_waitcnt lgkmcnt(3)
    v_mfma_f32_16x16x32_bf16 v[16:19], v[72:75], v[160:163], v[16:19]
    v_mfma_f32_16x16x32_bf16 v[20:23], v[72:75], v[164:167], v[20:23]
    s_waitcnt lgkmcnt(2)
    v_mfma_f32_16x16x32_bf16 v[16:19], v[76:79], v[168:171], v[16:19]
    v_mfma_f32_16x16x32_bf16 v[20:23], v[76:79], v[172:175], v[20:23]
    s_waitcnt lgkmcnt(1)
    v_mfma_f32_16x16x32_bf16 v[16:19], v[80:83], v[176:179], v[16:19]
    v_mfma_f32_16x16x32_bf16 v[20:23], v[80:83], v[180:183], v[20:23]
    s_waitcnt lgkmcnt(0)
    v_mfma_f32_16x16x32_bf16 v[16:19], v[84:87], v[184:187], v[16:19]
    v_mfma_f32_16x16x32_bf16 v[20:23], v[84:87], v[188:191], v[20:23]
    s_waitcnt vmcnt(4)
    ds_read_b128 v[72:75], v40 offset:49152
    ds_read_b128 v[76:79], v41 offset:49152
    ds_read_b128 v[80:83], v40 offset:57344
    ds_read_b128 v[84:87], v41 offset:57344
    s_waitcnt lgkmcnt(3)
    v_mfma_f32_16x16x32_bf16 v[16:19], v[72:75], v[192:195], v[16:19]
    v_mfma_f32_16x16x32_bf16 v[20:23], v[72:75], v[196:199], v[20:23]
    s_waitcnt lgkmcnt(2)
    v_mfma_f32_16x16x32_bf16 v[16:19], v[76:79], v[200:203], v[16:19]
    v_mfma_f32_16x16x32_bf16 v[20:23], v[76:79], v[204:207], v[20:23]
    s_waitcnt lgkmcnt(1)
    v_mfma_f32_16x16x32_bf16 v[16:19], v[80:83], v[208:211], v[16:19]
    v_mfma_f32_16x16x32_bf16 v[20:23], v[80:83], v[212:215], v[20:23]
    s_waitcnt lgkmcnt(0)
    v_mfma_f32_16x16x32_bf16 v[16:19], v[84:87], v[216:219], v[16:19]
    v_mfma_f32_16x16x32_bf16 v[20:23], v[84:87], v[220:223], v[20:23]
    v_add_u32 v40, 65536, v40
    v_add_u32 v41, 65536, v41
    s_waitcnt vmcnt(0)
    ds_read_b128 v[72:75], v40 offset:0
    ds_read_b128 v[76:79], v41 offset:0
    ds_read_b128 v[80:83], v40 offset:8192
    ds_read_b128 v[84:87], v41 offset:8192
    s_waitcnt lgkmcnt(3)
    v_mfma_f32_16x16x32_bf16 v[16:19], v[72:75], v[224:227], v[16:19]
    v_mfma_f32_16x16x32_bf16 v[20:23], v[72:75], v[228:231], v[20:23]
    s_waitcnt lgkmcnt(2)
    v_mfma_f32_16x16x32_bf16 v[16:19], v[76:79], v[232:235], v[16:19]
    v_mfma_f32_16x16x32_bf16 v[20:23], v[76:79], v[236:239], v[20:23]
    s_waitcnt lgkmcnt(1)
    v_mfma_f32_16x16x32_bf16 v[16:19], v[80:83], v[240:243], v[16:19]
    v_mfma_f32_16x16x32_bf16 v[20:23], v[80:83], v[244:247], v[20:23]
    s_waitcnt lgkmcnt(0)
    v_mfma_f32_16x16x32_bf16 v[16:19], v[84:87], v[248:251], v[16:19]
    v_mfma_f32_16x16x32_bf16 v[20:23], v[84:87], v[252:255], v[20:23]
    s_nop 6
    v_cvt_pk_bf16_f32 v64, v16, v17
    v_cvt_pk_bf16_f32 v65, v18, v19
    v_cvt_pk_bf16_f32 v66, v16, v17
    v_cvt_pk_bf16_f32 v67, v18, v19
    s_nop 0
    v_permlane32_swap_b32 v64, v66
    v_permlane32_swap_b32 v65, v67
    v_cvt_pk_bf16_f32 v68, v20, v21
    v_cvt_pk_bf16_f32 v69, v22, v23
    v_cvt_pk_bf16_f32 v70, v20, v21
    v_cvt_pk_bf16_f32 v71, v22, v23
    s_nop 0
    v_permlane32_swap_b32 v68, v70
    v_permlane32_swap_b32 v69, v71
    s_mov_b32 exec_hi, 0
    buffer_store_dwordx4 v[64:67], v6, s[44:47], s12 offen offset:1280 sc1
    v_cndmask_b32 v12, v68, v10, s[14:15]
    v_cndmask_b32 v13, v69, v10, s[14:15]
    v_cndmask_b32 v14, v70, v10, s[14:15]
    v_cndmask_b32 v15, v71, v10, s[14:15]
    s_mov_b32 exec_lo, 0x00ff000f
    buffer_store_dwordx4 v[12:15], v6, s[44:47], s12 offen offset:1536 sc1
    s_mov_b64 exec, -1
L_6:
    v_mov_b32 v8, 0
    s_cmp_ge_u32 s4, 4
    s_cbranch_scc1 L_7
    v_dot2c_f32_bf16 v8, v64, v64
    v_dot2c_f32_bf16 v8, v65, v65
    v_dot2c_f32_bf16 v8, v66, v66
    v_dot2c_f32_bf16 v8, v67, v67
    s_nop 2
    v_mov_b32 v9, v8
    s_nop 1
    v_permlane32_swap_b32 v8, v9
    v_add_f32 v8, v8, v9
    v_dot2c_f32_bf16 v8, v68, v68
    v_dot2c_f32_bf16 v8, v69, v69
    s_nop 2
    s_branch L_8
L_7:
    v_max3_f32 v8, v8, |v16|, |v17|
    v_max3_f32 v8, v8, |v18|, |v19|
    v_max3_f32 v8, v8, |v20|, |v21|
    v_max3_f32 v8, v8, |v22|, |v23|
    v_mov_b32 v9, v8
    s_nop 1
    v_permlane16_swap_b32 v8, v9
    v_max_f32 v8, v8, v9
    v_mov_b32 v9, v8
    s_nop 1
    v_permlane32_swap_b32 v8, v9
    v_max_f32 v8, v8, v9
    s_nop 1
L_8:
    v_max_f32_dpp v8, v8, v8 row_shr:1 row_mask:0xf bank_mask:0xf
    s_nop 1
    v_max_f32_dpp v8, v8, v8 row_shr:2 row_mask:0xf bank_mask:0xf
    s_nop 1
    v_max_f32_dpp v8, v8, v8 row_shr:4 row_mask:0xf bank_mask:0xf
    s_nop 1
    v_max_f32_dpp v8, v8, v8 row_shr:8 row_mask:0xf bank_mask:0xf
    s_nop 0
    v_readlane_b32 s69, v8, 15
    s_lshl_b32 s8, s3, 3
    s_add_u32 s8, s8, s4
    s_lshl_b32 s8, s8, 3
    s_getreg_b32 s9, hwreg(HW_REG_XCC_ID, 0, 4)
    s_andn2_b32 s69, s69, 15
    s_or_b32 s69, s69, s9
    v_mov_b32 v4, s69
    v_mov_b32 v5, s78
    v_mov_b32 v6, 0
    s_waitcnt vmcnt(0)
    s_mov_b64 exec, 1
    buffer_store_dwordx2 v[4:5], v6, s[44:47], s8 offen offset:1024 sc1
    s_mov_b64 exec, -1
    s_mul_i32 s68, s5, 4224
    s_add_u32 s68, s68, 27648
    v_and_b32 v4, 7, v1
    v_mul_u32_u24 v192, 528, v4
    v_lshrrev_b32 v5, 3, v1
    v_sub_u32 v193, 7, v5
    v_bfe_u32 v194, v193, 1, 1
    v_lshl_add_u32 v192, v194, 7, v192
    v_lshrrev_b32 v194, 2, v193
    v_lshl_add_u32 v192, v194, 6, v192
    v_and_b32 v194, 1, v193
    v_lshl_add_u32 v192, v194, 5, v192
    v_add_u32 v240, s68, v192
    v_lshrrev_b32 v193, 5, v1
    v_lshlrev_b32 v194, 4, v193
    v_add3_u32 v241, v62, v194, s68
    v_lshlrev_b32 v195, 12, v5
    v_lshl_add_u32 v242, v4, 4, v195
    v_mul_u32_u24 v195, 1280, v5
    v_lshl_add_u32 v195, v4, 2, v195
    s_lshl_b32 s8, s5, 5
    v_add_u32 v243, s8, v195
    s_mul_i32 s68, s5, 15360
    s_add_u32 s68, s68, 113920
    v_and_b32 v192, 31, v1
    v_lshlrev_b32 v236, 2, v192
    v_lshlrev_b32 v194, 2, v2
    v_lshlrev_b32 v195, 4, v3
    v_sub_u32 v195, v194, v195
    v_add3_u32 v228, v195, 48, s68
    v_add_u32 v229, 1024, v228
    v_add_u32 v230, 2048, v228
    v_add_u32 v231, 3072, v228
    v_lshrrev_b32 v194, 1, v2
    v_sub_u32 v194, 7, v194
    v_lshlrev_b32 v194, 6, v194
    v_and_b32 v195, 1, v2
    v_lshl_add_u32 v194, v195, 4, v194
    v_sub_u32 v195, 3, v3
    v_and_b32 v196, 1, v195
    v_lshl_add_u32 v194, v196, 5, v194
    v_lshrrev_b32 v195, 1, v195
    v_mul_u32_u24 v195, 5120, v195
    v_add3_u32 v232, v194, v195, s68
    v_lshrrev_b32 v194, 2, v2
    v_lshlrev_b32 v194, 7, v194
    v_lshl_add_u32 v194, v193, 9, v194
    v_and_b32 v195, 1, v3
    v_lshl_add_u32 v194, v195, 6, v194
    v_and_b32 v195, 3, v2
    v_lshl_add_u32 v234, v195, 4, v194
    v_mov_b32 v233, -1
    v_subrev_u32 v235, 64, v62
    v_cmp_lt_u32 s[8:9], 19, v1
    s_nop 1
    v_cndmask_b32 v192, 0, 1, s[8:9]
    v_mul_u32_u24 v193, 20, v192
    v_sub_u32 v193, v1, v193
    s_lshl_b32 s8, s76, 5
    s_lshl_b32 s9, s77, 3
    s_add_u32 s8, s8, s9
    s_add_u32 s8, s8, 1
    v_sub_u32 v194, s8, v192
    v_mul_u32_u24 v194, 1280, v194
    v_add_u32 v194, s64, v194
    v_lshl_add_u32 v195, v193, 3, s65
    v_lshl_add_u32 v49, v194, 1, v195
    v_add_u32 v48, v194, v195
    v_lshlrev_b32 v50, 1, v195
    v_lshlrev_b32 v195, 11, v195
    v_lshl_add_u32 v51, v192, 4, v195
    s_branch L_4
L_3:
    s_mul_i32 s68, s5, 4224
    s_add_u32 s68, s68, 27648
    v_and_b32 v4, 7, v1
    v_mul_u32_u24 v192, 528, v4
    v_lshrrev_b32 v5, 3, v1
    v_sub_u32 v193, 7, v5
    v_bfe_u32 v194, v193, 1, 1
    v_lshl_add_u32 v192, v194, 7, v192
    v_lshrrev_b32 v194, 2, v193
    v_lshl_add_u32 v192, v194, 6, v192
    v_and_b32 v194, 1, v193
    v_lshl_add_u32 v192, v194, 5, v192
    v_add_u32 v240, s68, v192
    v_lshrrev_b32 v193, 5, v1
    v_lshlrev_b32 v194, 4, v193
    v_add3_u32 v241, v62, v194, s68
    v_lshlrev_b32 v195, 12, v5
    v_lshl_add_u32 v242, v4, 4, v195
    v_mul_u32_u24 v195, 1280, v5
    v_lshl_add_u32 v195, v4, 2, v195
    s_lshl_b32 s8, s5, 5
    v_add_u32 v243, s8, v195
    s_mul_i32 s68, s5, 15360
    s_add_u32 s68, s68, 113920
    v_and_b32 v192, 31, v1
    v_lshlrev_b32 v236, 2, v192
    v_lshlrev_b32 v194, 2, v2
    v_lshlrev_b32 v195, 4, v3
    v_sub_u32 v195, v194, v195
    v_add3_u32 v228, v195, 48, s68
    v_add_u32 v229, 1024, v228
    v_add_u32 v230, 2048, v228
    v_add_u32 v231, 3072, v228
    v_lshrrev_b32 v194, 1, v2
    v_sub_u32 v194, 7, v194
    v_lshlrev_b32 v194, 6, v194
    v_and_b32 v195, 1, v2
    v_lshl_add_u32 v194, v195, 4, v194
    v_sub_u32 v195, 3, v3
    v_and_b32 v196, 1, v195
    v_lshl_add_u32 v194, v196, 5, v194
    v_lshrrev_b32 v195, 1, v195
    v_mul_u32_u24 v195, 5120, v195
    v_add3_u32 v232, v194, v195, s68
    v_lshrrev_b32 v194, 2, v2
    v_lshlrev_b32 v194, 7, v194
    v_lshl_add_u32 v194, v193, 9, v194
    v_and_b32 v195, 1, v3
    v_lshl_add_u32 v194, v195, 6, v194
    v_and_b32 v195, 3, v2
    v_lshl_add_u32 v234, v195, 4, v194
    v_mov_b32 v233, -1
    v_subrev_u32 v235, 64, v62
    v_cmp_lt_u32 s[8:9], 19, v1
    s_nop 1
    v_cndmask_b32 v192, 0, 1, s[8:9]
    v_mul_u32_u24 v193, 20, v192
    v_sub_u32 v193, v1, v193
    s_lshl_b32 s8, s76, 5
    s_lshl_b32 s9, s77, 3
    s_add_u32 s8, s8, s9
    s_add_u32 s8, s8, 1
    v_sub_u32 v194, s8, v192
    v_mul_u32_u24 v194, 1280, v194
    v_add_u32 v194, s64, v194
    v_lshl_add_u32 v195, v193, 3, s65
    v_lshl_add_u32 v49, v194, 1, v195
    v_add_u32 v48, v194, v195
    v_lshlrev_b32 v50, 1, v195
    v_lshlrev_b32 v195, 11, v195
    v_lshl_add_u32 v51, v192, 4, v195
    v_add_u32 v4, 0, v1
    v_mul_u32_u24 v5, 6554, v4
    v_lshrrev_b32 v5, 16, v5
    v_mul_u32_u24 v6, 10, v5
    v_sub_u32 v6, v4, v6
    v_mul_u32_u24 v5, 1280, v5
    v_lshl_add_u32 v244, v6, 4, v5
    v_add_u32 v4, 64, v1
    v_mul_u32_u24 v5, 6554, v4
    v_lshrrev_b32 v5, 16, v5
    v_mul_u32_u24 v6, 10, v5
    v_sub_u32 v6, v4, v6
    v_mul_u32_u24 v5, 1280, v5
    v_lshl_add_u32 v245, v6, 4, v5
    v_add_u32 v4, 128, v1
    v_mul_u32_u24 v5, 6554, v4
    v_lshrrev_b32 v5, 16, v5
    v_mul_u32_u24 v6, 10, v5
    v_sub_u32 v6, v4, v6
    v_mul_u32_u24 v5, 1280, v5
    v_lshl_add_u32 v246, v6, 4, v5
    v_add_u32 v4, 192, v1
    v_mul_u32_u24 v5, 6554, v4
    v_lshrrev_b32 v5, 16, v5
    v_mul_u32_u24 v6, 10, v5
    v_sub_u32 v6, v4, v6
    v_mul_u32_u24 v5, 1280, v5
    v_lshl_add_u32 v247, v6, 4, v5
    v_add_u32 v4, 256, v1
    v_mul_u32_u24 v5, 6554, v4
    v_lshrrev_b32 v5, 16, v5
    v_mul_u32_u24 v6, 10, v5
    v_sub_u32 v6, v4, v6
    v_mul_u32_u24 v5, 1280, v5
    v_lshl_add_u32 v248, v6, 4, v5
    v_mov_b32 v224, -1
    v_mov_b32 v225, -1
    v_mov_b32 v226, -1
    v_mov_b32 v227, -1
    s_cmp_lg_u32 s5, 3
    s_cbranch_scc1 L_9
    v_add_u32 v4, 0, v1
    v_mul_u32_u24 v5, 6554, v4
    v_lshrrev_b32 v5, 16, v5
    v_mul_u32_u24 v6, 10, v5
    v_sub_u32 v6, v4, v6
    v_lshlrev_b32 v6, 4, v6
    v_lshrrev_b32 v7, 1, v5
    v_and_b32 v7, 4, v7
    v_xor_b32 v5, v5, v7
    v_lshrrev_b32 v7, 3, v5
    v_lshl_add_u32 v4, v7, 1, v5
    v_mul_u32_u24 v4, 1280, v4
    v_add_u32 v224, v4, v6
    v_lshrrev_b32 v7, 1, v5
    v_lshl_add_u32 v4, v7, 3, v5
    v_add_u32 v4, 8, v4
    v_mul_u32_u24 v4, 1280, v4
    v_add_u32 v229, v4, v6
    v_add_u32 v4, 64, v1
    v_mul_u32_u24 v5, 6554, v4
    v_lshrrev_b32 v5, 16, v5
    v_mul_u32_u24 v6, 10, v5
    v_sub_u32 v6, v4, v6
    v_lshlrev_b32 v6, 4, v6
    v_lshrrev_b32 v7, 1, v5
    v_and_b32 v7, 4, v7
    v_xor_b32 v5, v5, v7
    v_lshrrev_b32 v7, 3, v5
    v_lshl_add_u32 v4, v7, 1, v5
    v_mul_u32_u24 v4, 1280, v4
    v_add_u32 v225, v4, v6
    v_lshrrev_b32 v7, 1, v5
    v_lshl_add_u32 v4, v7, 3, v5
    v_add_u32 v4, 8, v4
    v_mul_u32_u24 v4, 1280, v4
    v_add_u32 v230, v4, v6
    v_add_u32 v4, 128, v1
    v_mul_u32_u24 v5, 6554, v4
    v_lshrrev_b32 v5, 16, v5
    v_mul_u32_u24 v6, 10, v5
    v_sub_u32 v6, v4, v6
    v_lshlrev_b32 v6, 4, v6
    v_lshrrev_b32 v7, 1, v5
    v_and_b32 v7, 4, v7
    v_xor_b32 v5, v5, v7
    v_lshrrev_b32 v7, 3, v5
    v_lshl_add_u32 v4, v7, 1, v5
    v_mul_u32_u24 v4, 1280, v4
    v_add_u32 v226, v4, v6
    v_lshrrev_b32 v7, 1, v5
    v_lshl_add_u32 v4, v7, 3, v5
    v_add_u32 v4, 8, v4
    v_mul_u32_u24 v4, 1280, v4
    v_add_u32 v231, v4, v6
    v_add_u32 v4, 192, v1
    v_mul_u32_u24 v5, 6554, v4
    v_lshrrev_b32 v5, 16, v5
    v_mul_u32_u24 v6, 10, v5
    v_sub_u32 v6, v4, v6
    v_lshlrev_b32 v6, 4, v6
    v_lshrrev_b32 v7, 1, v5
    v_and_b32 v7, 4, v7
    v_xor_b32 v5, v5, v7
    v_lshrrev_b32 v7, 3, v5
    v_lshl_add_u32 v4, v7, 1, v5
    v_mul_u32_u24 v4, 1280, v4
    v_add_u32 v227, v4, v6
    v_lshrrev_b32 v7, 1, v5
    v_lshl_add_u32 v4, v7, 3, v5
    v_add_u32 v4, 8, v4
    v_mul_u32_u24 v4, 1280, v4
    v_add_u32 v232, v4, v6
    v_add_u32 v4, 256, v1
    v_mul_u32_u24 v5, 6554, v4
    v_lshrrev_b32 v5, 16, v5
    v_mul_u32_u24 v6, 10, v5
    v_sub_u32 v6, v4, v6
    v_lshlrev_b32 v6, 4, v6
    v_lshrrev_b32 v7, 1, v5
    v_and_b32 v7, 4, v7
    v_xor_b32 v5, v5, v7
    v_lshrrev_b32 v7, 3, v5
    v_lshl_add_u32 v4, v7, 1, v5
    v_mul_u32_u24 v4, 1280, v4
    v_add_u32 v228, v4, v6
    v_lshrrev_b32 v7, 1, v5
    v_lshl_add_u32 v4, v7, 3, v5
    v_add_u32 v4, 8, v4
    v_mul_u32_u24 v4, 1280, v4
    v_add_u32 v233, v4, v6
L_9:
    s_waitcnt lgkmcnt(0)
    s_load_dword s78, s[42:43], 0
    s_mov_b32 s48, s28
    s_mov_b32 s49, s29
    s_mov_b32 s50, 2621440
    s_mov_b32 s51, 0x20000
    s_mov_b32 s44, s42
    s_mov_b32 s45, s43
    s_mov_b32 s46, 10747904
    s_mov_b32 s47, 0x20000
    s_mov_b32 s56, s32
    s_mov_b32 s57, s33
    s_mov_b32 s58, 25600
    s_mov_b32 s59, 0x20000
    v_lshlrev_b32 v4, 7, v1
    s_sub_u32 s8, s5, 1
    s_lshl_b32 s8, s8, 13
    s_cmp_ge_u32 s2, 8
    s_cbranch_scc1 L_10
    buffer_load_dword v5, v4, s[44:47], s8 offen sc1
L_10:
    s_waitcnt lgkmcnt(0)
    s_mul_i32 s78, s78, 0x9E3779B1
    s_add_u32 s78, s78, 0x7F4A7C15
    s_setprio 0
    s_barrier
    s_add_u32 s8, s10, s12
    s_add_u32 s9, s8, 10240
    s_add_u32 m0, s11, 0
    s_nop 0
    buffer_load_dwordx4 v28, s[48:51], s8 offen offset:0 lds
    s_add_u32 m0, s11, 1024
    s_nop 0
    buffer_load_dwordx4 v29, s[48:51], s9 offen offset:0 lds
    s_add_u32 m0, s11, 8064
    s_nop 0
    buffer_load_dwordx4 v28, s[48:51], s8 offen offset:128 lds
    s_add_u32 m0, s11, 9088
    s_nop 0
    buffer_load_dwordx4 v29, s[48:51], s9 offen offset:128 lds
    s_add_u32 s12, s12, 256
    s_cmp_ge_u32 s12, 1280
    s_cselect_b32 s12, 0, s12
    s_add_u32 s8, s10, s12
    s_add_u32 s9, s8, 10240
    s_add_u32 m0, s11, 16384
    s_nop 0
    buffer_load_dwordx4 v28, s[48:51], s8 offen offset:0 lds
    s_add_u32 m0, s11, 17408
    s_nop 0
    buffer_load_dwordx4 v29, s[48:51], s9 offen offset:0 lds
    s_add_u32 m0, s11, 24448
    s_nop 0
    buffer_load_dwordx4 v28, s[48:51], s8 offen offset:128 lds
    s_add_u32 m0, s11, 25472
    s_nop 0
    buffer_load_dwordx4 v29, s[48:51], s9 offen offset:128 lds
    s_add_u32 s12, s12, 256
    s_cmp_ge_u32 s12, 1280
    s_cselect_b32 s12, 0, s12
    s_add_u32 s8, s10, s12
    s_add_u32 s9, s8, 10240
    s_add_u32 m0, s11, 32768
    s_nop 0
    buffer_load_dwordx4 v28, s[48:51], s8 offen offset:0 lds
    s_add_u32 m0, s11, 33792
    s_nop 0
    buffer_load_dwordx4 v29, s[48:51], s9 offen offset:0 lds
    s_add_u32 m0, s11, 40832
    s_nop 0
    buffer_load_dwordx4 v28, s[48:51], s8 offen offset:128 lds
    s_add_u32 m0, s11, 41856
    s_nop 0
    buffer_load_dwordx4 v29, s[48:51], s9 offen offset:128 lds
    s_add_u32 s12, s12, 256
    s_cmp_ge_u32 s12, 1280
    s_cselect_b32 s12, 0, s12
    s_add_u32 s8, s10, s12
    s_add_u32 s9, s8, 10240
    s_add_u32 m0, s11, 49152
    s_nop 0
    buffer_load_dwordx4 v28, s[48:51], s8 offen offset:0 lds
    s_add_u32 m0, s11, 50176
    s_nop 0
    buffer_load_dwordx4 v29, s[48:51], s9 offen offset:0 lds
    s_add_u32 m0, s11, 57216
    s_nop 0
    buffer_load_dwordx4 v28, s[48:51], s8 offen offset:128 lds
    s_add_u32 m0, s11, 58240
    s_nop 0
    buffer_load_dwordx4 v29, s[48:51], s9 offen offset:128 lds
    s_add_u32 s12, s12, 256
    s_cmp_ge_u32 s12, 1280
    s_cselect_b32 s12, 0, s12
    s_add_u32 s8, s10, s12
    s_add_u32 s9, s8, 10240
    s_add_u32 m0, s11, 65536
    s_nop 0
    buffer_load_dwordx4 v28, s[48:51], s8 offen offset:0 lds
    s_add_u32 m0, s11, 66560
    s_nop 0
    buffer_load_dwordx4 v29, s[48:51], s9 offen offset:0 lds
    s_add_u32 m0, s11, 73600
    s_nop 0
    buffer_load_dwordx4 v28, s[48:51], s8 offen offset:128 lds
    s_add_u32 m0, s11, 74624
    s_nop 0
    buffer_load_dwordx4 v29, s[48:51], s9 offen offset:128 lds
    s_setprio 0
    s_waitcnt vmcnt(16)
L_4:
    s_barrier
    ds_read_b128 v[96:99], v34 offset:0
    ds_read_b128 v[100:103], v35 offset:0
    ds_read_b64_tr_b16 v[104:105], v36 offset:0
    ds_read_b64_tr_b16 v[106:107], v37 offset:0
    ds_read_b64_tr_b16 v[108:109], v36 offset:32
    ds_read_b64_tr_b16 v[110:111], v37 offset:32
    ds_read_b64_tr_b16 v[112:113], v36 offset:64
    ds_read_b64_tr_b16 v[114:115], v37 offset:64
    ds_read_b128 v[116:119], v34 offset:8192
    ds_read_b128 v[120:123], v35 offset:8192
    ds_read_b64_tr_b16 v[124:125], v36 offset:10240
    ds_read_b64_tr_b16 v[126:127], v37 offset:10240
    ds_read_b64_tr_b16 v[128:129], v36 offset:10272
    ds_read_b64_tr_b16 v[130:131], v37 offset:10272
    ds_read_b64_tr_b16 v[132:133], v36 offset:10304
    ds_read_b64_tr_b16 v[134:135], v37 offset:10304
    s_waitcnt lgkmcnt(8)
    v_mfma_f32_16x16x32_bf16 v[64:67], v[104:107], v[96:99], 0
    v_mfma_f32_16x16x32_bf16 v[76:79], v[104:107], v[100:103], 0
    v_mfma_f32_16x16x32_bf16 v[68:71], v[108:111], v[96:99], 0
    v_mfma_f32_16x16x32_bf16 v[80:83], v[108:111], v[100:103], 0
    v_mfma_f32_16x16x32_bf16 v[72:75], v[112:115], v[96:99], 0
    v_mfma_f32_16x16x32_bf16 v[84:87], v[112:115], v[100:103], 0
    s_waitcnt lgkmcnt(0)
    v_mfma_f32_16x16x32_bf16 v[64:67], v[124:127], v[116:119], v[64:67]
    v_mfma_f32_16x16x32_bf16 v[76:79], v[124:127], v[120:123], v[76:79]
    v_mfma_f32_16x16x32_bf16 v[68:71], v[128:131], v[116:119], v[68:71]
    v_mfma_f32_16x16x32_bf16 v[80:83], v[128:131], v[120:123], v[80:83]
    v_mfma_f32_16x16x32_bf16 v[72:75], v[132:135], v[116:119], v[72:75]
    v_mfma_f32_16x16x32_bf16 v[84:87], v[132:135], v[120:123], v[84:87]
    s_waitcnt vmcnt(0)
    s_barrier
    ds_read_b128 v[96:99], v34 offset:16384
    ds_read_b128 v[100:103], v35 offset:16384
    ds_read_b64_tr_b16 v[104:105], v36 offset:20480
    ds_read_b64_tr_b16 v[106:107], v37 offset:20480
    ds_read_b64_tr_b16 v[108:109], v36 offset:20512
    ds_read_b64_tr_b16 v[110:111], v37 offset:20512
    ds_read_b64_tr_b16 v[112:113], v36 offset:20544
    ds_read_b64_tr_b16 v[114:115], v37 offset:20544
    ds_read_b128 v[116:119], v34 offset:24576
    ds_read_b128 v[120:123], v35 offset:24576
    ds_read_b64_tr_b16 v[124:125], v36 offset:30720
    ds_read_b64_tr_b16 v[126:127], v37 offset:30720
    ds_read_b64_tr_b16 v[128:129], v36 offset:30752
    ds_read_b64_tr_b16 v[130:131], v37 offset:30752
    ds_read_b64_tr_b16 v[132:133], v36 offset:30784
    ds_read_b64_tr_b16 v[134:135], v37 offset:30784
    s_waitcnt lgkmcnt(8)
    v_mfma_f32_16x16x32_bf16 v[64:67], v[104:107], v[96:99], v[64:67]
    v_mfma_f32_16x16x32_bf16 v[76:79], v[104:107], v[100:103], v[76:79]
    v_mfma_f32_16x16x32_bf16 v[68:71], v[108:111], v[96:99], v[68:71]
    v_mfma_f32_16x16x32_bf16 v[80:83], v[108:111], v[100:103], v[80:83]
    v_mfma_f32_16x16x32_bf16 v[72:75], v[112:115], v[96:99], v[72:75]
    v_mfma_f32_16x16x32_bf16 v[84:87], v[112:115], v[100:103], v[84:87]
    s_waitcnt lgkmcnt(0)
    v_mfma_f32_16x16x32_bf16 v[64:67], v[124:127], v[116:119], v[64:67]
    v_mfma_f32_16x16x32_bf16 v[76:79], v[124:127], v[120:123], v[76:79]
    v_mfma_f32_16x16x32_bf16 v[68:71], v[128:131], v[116:119], v[68:71]
    v_mfma_f32_16x16x32_bf16 v[80:83], v[128:131], v[120:123], v[80:83]
    v_mfma_f32_16x16x32_bf16 v[72:75], v[132:135], v[116:119], v[72:75]
    v_mfma_f32_16x16x32_bf16 v[84:87], v[132:135], v[120:123], v[84:87]
    v_add_u32 v36, 40960, v36
    v_add_u32 v37, 40960, v37
    s_barrier
    ds_read_b128 v[96:99], v34 offset:32768
    ds_read_b128 v[100:103], v35 offset:32768
    ds_read_b64_tr_b16 v[104:105], v36 offset:0
    ds_read_b64_tr_b16 v[106:107], v37 offset:0
    ds_read_b64_tr_b16 v[108:109], v36 offset:32
    ds_read_b64_tr_b16 v[110:111], v37 offset:32
    ds_read_b64_tr_b16 v[112:113], v36 offset:64
    ds_read_b64_tr_b16 v[114:115], v37 offset:64
    ds_read_b128 v[116:119], v34 offset:40960
    ds_read_b128 v[120:123], v35 offset:40960
    ds_read_b64_tr_b16 v[124:125], v36 offset:10240
    ds_read_b64_tr_b16 v[126:127], v37 offset:10240
    ds_read_b64_tr_b16 v[128:129], v36 offset:10272
    ds_read_b64_tr_b16 v[130:131], v37 offset:10272
    ds_read_b64_tr_b16 v[132:133], v36 offset:10304
    ds_read_b64_tr_b16 v[134:135], v37 offset:10304
    ds_read_b128 v[136:139], v34 offset:49152
    ds_read_b128 v[140:143], v35 offset:49152
    ds_read_b64_tr_b16 v[144:145], v36 offset:20480
    ds_read_b64_tr_b16 v[146:147], v37 offset:20480
    ds_read_b64_tr_b16 v[148:149], v36 offset:20512
    ds_read_b64_tr_b16 v[150:151], v37 offset:20512
    ds_read_b64_tr_b16 v[152:153], v36 offset:20544
    ds_read_b64_tr_b16 v[154:155], v37 offset:20544
    ds_read_b128 v[156:159], v34 offset:57344
    ds_read_b128 v[160:163], v35 offset:57344
    ds_read_b64_tr_b16 v[164:165], v36 offset:30720
    ds_read_b64_tr_b16 v[166:167], v37 offset:30720
    ds_read_b64_tr_b16 v[168:169], v36 offset:30752
    ds_read_b64_tr_b16 v[170:171], v37 offset:30752
    ds_read_b64_tr_b16 v[172:173], v36 offset:30784
    ds_read_b64_tr_b16 v[174:175], v37 offset:30784
    s_cmp_lg_u32 s5, 1
    s_cbranch_scc1 L_11
    buffer_load_dwordx4 v[8:11], v45, s[44:47], 0 offen offset:1024 sc1
    buffer_load_dwordx4 v[12:15], v45, s[44:47], 0 offen offset:1040 sc1
L_11:
    s_waitcnt lgkmcnt(15)
    v_mfma_f32_16x16x32_bf16 v[64:67], v[104:107], v[96:99], v[64:67]
    v_mfma_f32_16x16x32_bf16 v[76:79], v[104:107], v[100:103], v[76:79]
    v_mfma_f32_16x16x32_bf16 v[68:71], v[108:111], v[96:99], v[68:71]
    v_mfma_f32_16x16x32_bf16 v[80:83], v[108:111], v[100:103], v[80:83]
    v_mfma_f32_16x16x32_bf16 v[72:75], v[112:115], v[96:99], v[72:75]
    v_mfma_f32_16x16x32_bf16 v[84:87], v[112:115], v[100:103], v[84:87]
    s_waitcnt lgkmcnt(15)
    v_mfma_f32_16x16x32_bf16 v[64:67], v[124:127], v[116:119], v[64:67]
    v_mfma_f32_16x16x32_bf16 v[76:79], v[124:127], v[120:123], v[76:79]
    v_mfma_f32_16x16x32_bf16 v[68:71], v[128:131], v[116:119], v[68:71]
    v_mfma_f32_16x16x32_bf16 v[80:83], v[128:131], v[120:123], v[80:83]
    v_mfma_f32_16x16x32_bf16 v[72:75], v[132:135], v[116:119], v[72:75]
    v_mfma_f32_16x16x32_bf16 v[84:87], v[132:135], v[120:123], v[84:87]
    s_waitcnt lgkmcnt(8)
    v_mfma_f32_16x16x32_bf16 v[64:67], v[144:147], v[136:139], v[64:67]
    v_mfma_f32_16x16x32_bf16 v[76:79], v[144:147], v[140:143], v[76:79]
    v_mfma_f32_16x16x32_bf16 v[68:71], v[148:151], v[136:139], v[68:71]
    v_mfma_f32_16x16x32_bf16 v[80:83], v[148:151], v[140:143], v[80:83]
    v_mfma_f32_16x16x32_bf16 v[72:75], v[152:155], v[136:139], v[72:75]
    v_mfma_f32_16x16x32_bf16 v[84:87], v[152:155], v[140:143], v[84:87]
    s_waitcnt lgkmcnt(0)
    v_mfma_f32_16x16x32_bf16 v[64:67], v[164:167], v[156:159], v[64:67]
    v_mfma_f32_16x16x32_bf16 v[76:79], v[164:167], v[160:163], v[76:79]
    v_mfma_f32_16x16x32_bf16 v[68:71], v[168:171], v[156:159], v[68:71]
    v_mfma_f32_16x16x32_bf16 v[80:83], v[168:171], v[160:163], v[80:83]
    v_mfma_f32_16x16x32_bf16 v[72:75], v[172:175], v[156:159], v[72:75]
    v_mfma_f32_16x16x32_bf16 v[84:87], v[172:175], v[160:163], v[84:87]
    v_add_u32 v36, 4294926336, v36
    v_add_u32 v37, 4294926336, v37
    v_add_u32 v34, 65536, v34
    v_add_u32 v35, 65536, v35
    s_cmp_lg_u32 s5, 1
    s_cbranch_scc1 L_12
    s_mov_b32 s96, 131072
    s_branch L_15
L_13:
    buffer_load_dwordx4 v[8:11], v45, s[44:47], 0 offen offset:1024 sc1
    buffer_load_dwordx4 v[12:15], v45, s[44:47], 0 offen offset:1040 sc1
L_15:
    s_waitcnt vmcnt(0)
    v_cmp_ne_u32 s[8:9], s78, v9
    v_cmp_ne_u32 vcc, s78, v11
    s_nop 0
    s_or_b64 s[8:9], s[8:9], vcc
    v_cmp_ne_u32 vcc, s78, v13
    s_nop 0
    s_or_b64 s[8:9], s[8:9], vcc
    v_cmp_ne_u32 vcc, s78, v15
    s_nop 0
    s_or_b64 s[8:9], s[8:9], vcc
    s_cmp_eq_u64 s[8:9], 0
    s_cbranch_scc1 L_14
    s_sleep 1
    s_sub_u32 s96, s96, 1
    s_cmp_lg_u32 s96, 0
    s_cbranch_scc1 L_13
L_14:
L_12:
    s_cmp_lg_u32 s5, 2
    s_cbranch_scc1 L_16
    v_mov_b32 v4, 0
    v_mov_b32 v5, 0
    v_mov_b32 v6, 0
    v_mov_b32 v7, 8
    ds_write_b64 v44, v[4:5]
    ds_write_b32 v44, v4 offset:8
    ds_write_b32 v44, v7 offset:16
L_16:
    s_barrier
    ds_read_b128 v[96:99], v34 offset:0
    ds_read_b128 v[100:103], v35 offset:0
    ds_read_b64_tr_b16 v[104:105], v36 offset:0
    ds_read_b64_tr_b16 v[106:107], v37 offset:0
    ds_read_b64_tr_b16 v[108:109], v36 offset:32
    ds_read_b64_tr_b16 v[110:111], v37 offset:32
    ds_read_b64_tr_b16 v[112:113], v36 offset:64
    ds_read_b64_tr_b16 v[114:115], v37 offset:64
    ds_read_b128 v[116:119], v34 offset:8192
    ds_read_b128 v[120:123], v35 offset:8192
    ds_read_b64_tr_b16 v[124:125], v36 offset:10240
    ds_read_b64_tr_b16 v[126:127], v37 offset:10240
    ds_read_b64_tr_b16 v[128:129], v36 offset:10272
    ds_read_b64_tr_b16 v[130:131], v37 offset:10272
    ds_read_b64_tr_b16 v[132:133], v36 offset:10304
    ds_read_b64_tr_b16 v[134:135], v37 offset:10304
    s_waitcnt lgkmcnt(8)
    v_mfma_f32_16x16x32_bf16 v[64:67], v[104:107], v[96:99], v[64:67]
    v_mfma_f32_16x16x32_bf16 v[76:79], v[104:107], v[100:103], v[76:79]
    v_mfma_f32_16x16x32_bf16 v[68:71], v[108:111], v[96:99], v[68:71]
    v_mfma_f32_16x16x32_bf16 v[80:83], v[108:111], v[100:103], v[80:83]
    v_mfma_f32_16x16x32_bf16 v[72:75], v[112:115], v[96:99], v[72:75]
    v_mfma_f32_16x16x32_bf16 v[84:87], v[112:115], v[100:103], v[84:87]
    s_waitcnt lgkmcnt(0)
    v_mfma_f32_16x16x32_bf16 v[64:67], v[124:127], v[116:119], v[64:67]
    v_mfma_f32_16x16x32_bf16 v[76:79], v[124:127], v[120:123], v[76:79]
    v_mfma_f32_16x16x32_bf16 v[68:71], v[128:131], v[116:119], v[68:71]
    v_mfma_f32_16x16x32_bf16 v[80:83], v[128:131], v[120:123], v[80:83]
    v_mfma_f32_16x16x32_bf16 v[72:75], v[132:135], v[116:119], v[72:75]
    v_mfma_f32_16x16x32_bf16 v[84:87], v[132:135], v[120:123], v[84:87]
    s_nop 3
    ds_write_b128 v46, v[76:79] offset:0
    s_nop 0
    ds_write_b128 v46, v[80:83] offset:1024
    s_nop 0
    ds_write_b128 v46, v[84:87] offset:2048
    s_cmp_lg_u32 s5, 3
    s_cbranch_scc1 L_17
    s_mov_b32 s60, s18
    s_mov_b32 s61, s19
    s_mov_b32 s62, 2621440
    s_mov_b32 s63, 0x20000
    s_add_u32 s8, s64, s65
    s_sub_u32 s8, s8, 5120
    v_add_u32 v4, s8, v244
    s_mov_b32 m0, 0
    s_nop 0
    buffer_load_dwordx4 v4, s[60:63], 0 offen lds
    v_add_u32 v4, s8, v245
    s_mov_b32 m0, 1024
    s_nop 0
    buffer_load_dwordx4 v4, s[60:63], 0 offen lds
    v_add_u32 v4, s8, v246
    s_mov_b32 m0, 2048
    s_nop 0
    buffer_load_dwordx4 v4, s[60:63], 0 offen lds
    v_add_u32 v4, s8, v247
    s_mov_b32 m0, 3072
    s_nop 0
    buffer_load_dwordx4 v4, s[60:63], 0 offen lds
    v_add_u32 v4, s8, v248
    s_mov_b32 m0, 4096
    s_nop 0
    buffer_load_dwordx4 v4, s[60:63], 0 offen lds
    s_add_u32 s8, s8, 40960
    s_mov_b32 m0, 5120
    s_nop 0
    buffer_load_dwordx4 v244, s[60:63], s8 offen lds
    s_mov_b32 m0, 6144
    s_nop 0
    buffer_load_dwordx4 v245, s[60:63], s8 offen lds
    s_mov_b32 m0, 7168
    s_nop 0
    buffer_load_dwordx4 v246, s[60:63], s8 offen lds
    s_mov_b32 m0, 8192
    s_nop 0
    buffer_load_dwordx4 v247, s[60:63], s8 offen lds
    s_mov_b32 m0, 9216
    s_nop 0
    buffer_load_dwordx4 v248, s[60:63], s8 offen lds
    s_add_u32 s8, s8, 40960
    s_mov_b32 m0, 10240
    s_nop 0
    buffer_load_dwordx4 v244, s[60:63], s8 offen lds
L_17:
    s_mov_b32 s8, 0xffff0000
    s_mov_b32 s9, 1051011932
    s_waitcnt lgkmcnt(0)
    s_barrier
    ds_read_b128 v[76:79], v47 offset:0
    ds_read_b128 v[80:83], v47 offset:1024
    ds_read_b128 v[84:87], v47 offset:2048
    s_waitcnt lgkmcnt(2)
    v_add_f32 v64, v64, v76
    v_add_f32 v65, v65, v77
    v_add_f32 v66, v66, v78
    v_add_f32 v67, v67, v79
    v_mul_f32 v64, s9, v64
    v_mul_f32 v65, s9, v65
    v_mul_f32 v66, s9, v66
    v_mul_f32 v67, s9, v67
    v_cvt_pk_bf16_f32 v88, v64, v65
    v_cvt_pk_bf16_f32 v89, v66, v67
    ds_write_b64 v38, v[88:89] offset:0
    s_waitcnt lgkmcnt(2)
    v_add_f32 v68, v68, v80
    v_add_f32 v69, v69, v81
    v_add_f32 v70, v70, v82
    v_add_f32 v71, v71, v83
    v_mul_f32 v68, s9, v68
    v_mul_f32 v69, s9, v69
    v_mul_f32 v70, s9, v70
    v_mul_f32 v71, s9, v71
    v_cvt_pk_bf16_f32 v90, v68, v69
    v_cvt_pk_bf16_f32 v91, v70, v71
    ds_write_b64 v38, v[90:91] offset:32
    s_waitcnt lgkmcnt(2)
    v_add_f32 v72, v72, v84
    v_add_f32 v73, v73, v85
    v_add_f32 v74, v74, v86
    v_add_f32 v75, v75, v87
    v_mul_f32 v72, s9, v72
    v_mul_f32 v73, s9, v73
    v_mul_f32 v74, s9, v74
    v_mul_f32 v75, s9, v75
    v_cvt_pk_bf16_f32 v92, v72, v73
    v_cvt_pk_bf16_f32 v93, v74, v75
    ds_write_b64 v38, v[92:93] offset:64
    s_waitcnt lgkmcnt(0)
    s_barrier
    s_cmp_lg_u32 s5, 3
    s_cbranch_scc1 L_19
    s_waitcnt vmcnt(6)
    s_mov_b32 s60, s20
    s_mov_b32 s61, s21
    s_mov_b32 s62, 2621440
    s_mov_b32 s63, 0x20000
    s_add_u32 s8, s64, s65
    s_sub_u32 s8, s8, 1280
    v_add_u32 v4, s8, v244
    s_mov_b32 m0, 16384
    s_nop 0
    buffer_load_dwordx4 v4, s[60:63], 0 offen lds
    v_add_u32 v4, s8, v245
    s_mov_b32 m0, 17408
    s_nop 0
    buffer_load_dwordx4 v4, s[60:63], 0 offen lds
    v_add_u32 v4, s8, v246
    s_mov_b32 m0, 18432
    s_nop 0
    buffer_load_dwordx4 v4, s[60:63], 0 offen lds
    v_add_u32 v4, s8, v247
    s_mov_b32 m0, 19456
    s_nop 0
    buffer_load_dwordx4 v4, s[60:63], 0 offen lds
    v_add_u32 v4, s8, v248
    s_mov_b32 m0, 20480
    s_nop 0
    buffer_load_dwordx4 v4, s[60:63], 0 offen lds
    s_add_u32 s8, s8, 40960
    s_mov_b32 m0, 21504
    s_nop 0
    buffer_load_dwordx4 v244, s[60:63], s8 offen lds
    s_mov_b32 m0, 22528
    s_nop 0
    buffer_load_dwordx4 v245, s[60:63], s8 offen lds
    s_mov_b32 m0, 23552
    s_nop 0
    buffer_load_dwordx4 v246, s[60:63], s8 offen lds
    s_mov_b32 m0, 24576
    s_nop 0
    buffer_load_dwordx4 v247, s[60:63], s8 offen lds
    s_mov_b32 m0, 25600
    s_nop 0
    buffer_load_dwordx4 v248, s[60:63], s8 offen lds
    s_add_u32 s8, s8, 40960
    s_mov_b32 m0, 26624
    s_nop 0
    buffer_load_dwordx4 v244, s[60:63], s8 offen lds
L_19:
    s_mov_b32 s60, s22
    s_mov_b32 s61, s23
    s_mov_b32 s62, 5120
    s_mov_b32 s63, 0x20000
    s_mov_b32 s52, s36
    s_mov_b32 s53, s37
    s_mov_b32 s54, 819200
    s_mov_b32 s55, 0x20000
    s_setprio 2
    v_and_b32 v4, 7, v1
    v_lshlrev_b32 v4, 4, v4
    s_lshl_b32 s8, s5, 7
    s_lshl_b32 s9, s65, 2
    s_add_u32 s8, s8, s9
    buffer_load_dwordx4 v[216:219], v4, s[60:63], s8 offen
    buffer_load_dwordx4 v[220:223], v4, s[60:63], s9 offen offset:512
    s_mov_b32 s12, 0xffff0000
    s_cmp_lg_u32 s5, 1
    s_cbranch_scc1 L_20
    v_mul_u32_u24 v4, 176, v1
    v_add_u32 v4, 102400, v4
    ds_read_b128 v[128:131], v4 offset:0
    ds_read_b128 v[132:135], v4 offset:16
    ds_read_b128 v[136:139], v4 offset:32
    ds_read_b128 v[140:143], v4 offset:48
    ds_read_b128 v[144:147], v4 offset:64
    ds_read_b128 v[148:151], v4 offset:80
    ds_read_b128 v[152:155], v4 offset:96
    ds_read_b128 v[156:159], v4 offset:112
    ds_read_b128 v[160:163], v4 offset:128
    ds_read_b128 v[164:167], v4 offset:144
    s_getreg_b32 s9, hwreg(HW_REG_XCC_ID, 0, 4)
    v_xor_b32 v5, s9, v8
    v_xor_b32 v6, s9, v10
    v_or_b32 v5, v5, v6
    v_xor_b32 v6, s9, v12
    v_xor_b32 v7, s9, v14
    v_or3_b32 v5, v5, v6, v7
    v_and_b32 v5, 15, v5
    v_cmp_ne_u32 vcc, 0, v5
    s_lshl_b32 s8, s3, 1
    s_lshr_b64 s[10:11], vcc, s8
    v_max_f32 v8, v8, v10
    v_max3_f32 v8, v8, v12, v14
    s_mov_b32 s8, 0x55555555
    s_mov_b32 s9, 0x55555555
    v_cndmask_b32 v10, 0, v8, s[8:9]
    v_cndmask_b32 v11, v8, 0, s[8:9]
    s_nop 0
    v_max_f32_dpp v10, v10, v10 row_shr:1 row_mask:0xf bank_mask:0xf
    v_max_f32_dpp v11, v11, v11 row_shr:1 row_mask:0xf bank_mask:0xf
    s_nop 0
    v_max_f32_dpp v10, v10, v10 row_shr:2 row_mask:0xf bank_mask:0xf
    v_max_f32_dpp v11, v11, v11 row_shr:2 row_mask:0xf bank_mask:0xf
    s_nop 0
    v_max_f32_dpp v10, v10, v10 row_shr:4 row_mask:0xf bank_mask:0xf
    v_max_f32_dpp v11, v11, v11 row_shr:4 row_mask:0xf bank_mask:0xf
    s_nop 0
    v_max_f32_dpp v10, v10, v10 row_shr:8 row_mask:0xf bank_mask:0xf
    v_max_f32_dpp v11, v11, v11 row_shr:8 row_mask:0xf bank_mask:0xf
    s_nop 0
    v_max_f32_dpp v10, v10, v10 row_bcast:15 row_mask:0xa bank_mask:0xf
    v_max_f32_dpp v11, v11, v11 row_bcast:15 row_mask:0xa bank_mask:0xf
    s_nop 0
    v_max_f32_dpp v10, v10, v10 row_bcast:31 row_mask:0xc bank_mask:0xf
    v_max_f32_dpp v11, v11, v11 row_bcast:31 row_mask:0xc bank_mask:0xf
    v_mov_b32 v12, 0
    v_mov_b32 v13, 0
    v_mov_b32 v14, 0
    v_mov_b32 v15, 0
    v_readlane_b32 s14, v10, 63
    v_readlane_b32 s15, v11, 63
    s_waitcnt lgkmcnt(0)
    v_dot2c_f32_bf16 v12, v128, v128
    v_dot2c_f32_bf16 v13, v138, v138
    v_dot2c_f32_bf16 v14, v148, v148
    v_dot2c_f32_bf16 v15, v158, v158
    v_dot2c_f32_bf16 v12, v129, v129
    v_dot2c_f32_bf16 v13, v139, v139
    v_dot2c_f32_bf16 v14, v149, v149
    v_dot2c_f32_bf16 v15, v159, v159
    v_dot2c_f32_bf16 v12, v130, v130
    v_dot2c_f32_bf16 v13, v140, v140
    v_dot2c_f32_bf16 v14, v150, v150
    v_dot2c_f32_bf16 v15, v160, v160
    v_dot2c_f32_bf16 v12, v131, v131
    v_dot2c_f32_bf16 v13, v141, v141
    v_dot2c_f32_bf16 v14, v151, v151
    v_dot2c_f32_bf16 v15, v161, v161
    v_dot2c_f32_bf16 v12, v132, v132
    v_dot2c_f32_bf16 v13, v142, v142
    v_dot2c_f32_bf16 v14, v152, v152
    v_dot2c_f32_bf16 v15, v162, v162
    v_dot2c_f32_bf16 v12, v133, v133
    v_dot2c_f32_bf16 v13, v143, v143
    v_dot2c_f32_bf16 v14, v153, v153
    v_dot2c_f32_bf16 v15, v163, v163
    v_dot2c_f32_bf16 v12, v134, v134
    v_dot2c_f32_bf16 v13, v144, v144
    v_dot2c_f32_bf16 v14, v154, v154
    v_dot2c_f32_bf16 v15, v164, v164
    v_dot2c_f32_bf16 v12, v135, v135
    v_dot2c_f32_bf16 v13, v145, v145
    v_dot2c_f32_bf16 v14, v155, v155
    v_dot2c_f32_bf16 v15, v165, v165
    v_dot2c_f32_bf16 v12, v136, v136
    v_dot2c_f32_bf16 v13, v146, v146
    v_dot2c_f32_bf16 v14, v156, v156
    v_dot2c_f32_bf16 v15, v166, v166
    v_dot2c_f32_bf16 v12, v137, v137
    v_dot2c_f32_bf16 v13, v147, v147
    v_dot2c_f32_bf16 v14, v157, v157
    v_dot2c_f32_bf16 v15, v167, v167
    s_nop 1
    v_max3_f32 v12, v12, v13, v14
    v_max_f32 v12, v12, v15
    v_mul_f32 v12, s14, v12
    v_cmp_nge_f32 vcc, 1166016512, v12
    s_mov_b32 s8, 1
    s_cmp_lg_u64 vcc, 0
    s_cselect_b32 s8, 0x101, s8
    s_cmp_lt_u32 s15, 830472192
    s_cselect_b32 s8, 0x101, s8
    s_cmp_gt_u32 s15, 1484783616
    s_cselect_b32 s8, 0x101, s8
    s_and_b32 s10, s10, 3
    s_cselect_b32 s9, 0, 512
    s_or_b32 s8, s8, s9
    v_mov_b32 v4, s8
    s_mov_b64 exec, 1
    ds_add_u32 v44, v4 offset:8
    s_mov_b64 exec, -1
L_20:
    s_or_b32 s8, s2, s5
    s_cmp_lg_u32 s8, 0
    s_cbranch_scc1 L_21
    s_mov_b32 s8, 0
    v_mov_b32 v6, s78
    v_mov_b32 v7, 0
    s_mov_b64 exec, 1
    buffer_store_dword v6, v7, s[44:47], s8 offen sc1
    s_mov_b64 exec, -1
L_21:
    s_waitcnt vmcnt(0)
    s_cmp_lg_u32 s5, 3
    s_cbranch_scc1 L_22
    v_mov_b32 v4, 1
    s_mov_b64 exec, 1
    ds_add_u32 v44, v4 offset:0
    s_mov_b64 exec, -1
L_22:
    s_mov_b32 s96, 131072
L_23:
    ds_read_b32 v4, v44 offset:0
    s_waitcnt lgkmcnt(0)
    v_cmp_ne_u32 s[8:9], 1, v4
    s_nop 0
    s_cmp_eq_u64 s[8:9], 0
    s_cbranch_scc1 L_24
    s_sleep 2
    s_sub_u32 s96, s96, 1
    s_cmp_lg_u32 s96, 0
    s_cbranch_scc1 L_23
L_24:
    ds_read_b32 v192, v243 offset:0
    ds_read_b32 v193, v243 offset:160
    ds_read_b32 v194, v243 offset:320
    ds_read_b32 v195, v243 offset:480
    ds_read_b32 v196, v243 offset:640
    ds_read_b32 v197, v243 offset:800
    ds_read_b32 v198, v243 offset:960
    ds_read_b32 v199, v243 offset:1120
    ds_read_b32 v200, v243 offset:1280
    ds_read_b32 v201, v243 offset:1440
    ds_read_b32 v202, v243 offset:1600
    ds_read_b32 v203, v243 offset:1760
    ds_read_b32 v204, v243 offset:16384
    ds_read_b32 v205, v243 offset:16544
    ds_read_b32 v206, v243 offset:16704
    ds_read_b32 v207, v243 offset:16864
    ds_read_b32 v208, v243 offset:17024
    ds_read_b32 v209, v243 offset:17184
    ds_read_b32 v210, v243 offset:17344
    ds_read_b32 v211, v243 offset:17504
    ds_read_b32 v212, v243 offset:17664
    v_lshlrev_b32 v170, 16, v216
    v_lshlrev_b32 v171, 16, v218
    v_and_b32 v172, s12, v216
    v_and_b32 v173, s12, v218
    v_lshlrev_b32 v174, 16, v217
    v_lshlrev_b32 v175, 16, v219
    v_and_b32 v176, s12, v217
    v_and_b32 v177, s12, v219
    s_waitcnt lgkmcnt(9)
    v_lshlrev_b32 v128, 16, v192
    v_and_b32 v129, s12, v192
    v_lshlrev_b32 v130, 16, v193
    v_and_b32 v131, s12, v193
    v_lshlrev_b32 v132, 16, v194
    v_and_b32 v133, s12, v194
    v_lshlrev_b32 v134, 16, v195
    v_and_b32 v135, s12, v195
    v_lshlrev_b32 v136, 16, v196
    v_and_b32 v137, s12, v196
    v_lshlrev_b32 v138, 16, v197
    v_and_b32 v139, s12, v197
    v_lshlrev_b32 v140, 16, v198
    v_and_b32 v141, s12, v198
    v_lshlrev_b32 v142, 16, v199
    v_and_b32 v143, s12, v199
    v_lshlrev_b32 v144, 16, v200
    v_and_b32 v145, s12, v200
    v_lshlrev_b32 v146, 16, v201
    v_and_b32 v147, s12, v201
    v_lshlrev_b32 v148, 16, v202
    v_and_b32 v149, s12, v202
    v_lshlrev_b32 v150, 16, v203
    v_and_b32 v151, s12, v203
    v_mul_f32 v64, v128, v176
    v_mul_f32 v65, v129, v177
    v_mul_f32 v66, v130, v176
    v_mul_f32 v67, v131, v177
    v_mul_f32 v68, v132, v176
    v_mul_f32 v69, v133, v177
    v_mul_f32 v70, v134, v176
    v_mul_f32 v71, v135, v177
    v_mul_f32 v72, v136, v176
    v_mul_f32 v73, v137, v177
    v_mul_f32 v74, v138, v176
    v_mul_f32 v75, v139, v177
    v_mul_f32 v76, v140, v176
    v_mul_f32 v77, v141, v177
    v_mul_f32 v78, v142, v176
    v_mul_f32 v79, v143, v177
    v_mul_f32 v80, v144, v176
    v_mul_f32 v81, v145, v177
    v_fmac_f32 v64, v130, v174
    v_fmac_f32 v65, v131, v175
    v_fmac_f32 v66, v132, v174
    v_fmac_f32 v67, v133, v175
    v_fmac_f32 v68, v134, v174
    v_fmac_f32 v69, v135, v175
    v_fmac_f32 v70, v136, v174
    v_fmac_f32 v71, v137, v175
    v_fmac_f32 v72, v138, v174
    v_fmac_f32 v73, v139, v175
    v_fmac_f32 v74, v140, v174
    v_fmac_f32 v75, v141, v175
    v_fmac_f32 v76, v142, v174
    v_fmac_f32 v77, v143, v175
    v_fmac_f32 v78, v144, v174
    v_fmac_f32 v79, v145, v175
    v_fmac_f32 v80, v146, v174
    v_fmac_f32 v81, v147, v175
    v_fmac_f32 v64, v132, v172
    v_fmac_f32 v65, v133, v173
    v_fmac_f32 v66, v134, v172
    v_fmac_f32 v67, v135, v173
    v_fmac_f32 v68, v136, v172
    v_fmac_f32 v69, v137, v173
    v_fmac_f32 v70, v138, v172
    v_fmac_f32 v71, v139, v173
    v_fmac_f32 v72, v140, v172
    v_fmac_f32 v73, v141, v173
    v_fmac_f32 v74, v142, v172
    v_fmac_f32 v75, v143, v173
    v_fmac_f32 v76, v144, v172
    v_fmac_f32 v77, v145, v173
    v_fmac_f32 v78, v146, v172
    v_fmac_f32 v79, v147, v173
    v_fmac_f32 v80, v148, v172
    v_fmac_f32 v81, v149, v173
    v_fmac_f32 v64, v134, v170
    v_fmac_f32 v65, v135, v171
    v_fmac_f32 v66, v136, v170
    v_fmac_f32 v67, v137, v171
    v_fmac_f32 v68, v138, v170
    v_fmac_f32 v69, v139, v171
    v_fmac_f32 v70, v140, v170
    v_fmac_f32 v71, v141, v171
    v_fmac_f32 v72, v142, v170
    v_fmac_f32 v73, v143, v171
    v_fmac_f32 v74, v144, v170
    v_fmac_f32 v75, v145, v171
    v_fmac_f32 v76, v146, v170
    v_fmac_f32 v77, v147, v171
    v_fmac_f32 v78, v148, v170
    v_fmac_f32 v79, v149, v171
    v_fmac_f32 v80, v150, v170
    v_fmac_f32 v81, v151, v171
    s_waitcnt lgkmcnt(0)
    v_lshlrev_b32 v152, 16, v204
    v_and_b32 v153, s12, v204
    v_lshlrev_b32 v154, 16, v205
    v_and_b32 v155, s12, v205
    v_lshlrev_b32 v156, 16, v206
    v_and_b32 v157, s12, v206
    v_lshlrev_b32 v158, 16, v207
    v_and_b32 v159, s12, v207
    v_lshlrev_b32 v160, 16, v208
    v_and_b32 v161, s12, v208
    v_lshlrev_b32 v162, 16, v209
    v_and_b32 v163, s12, v209
    v_lshlrev_b32 v164, 16, v210
    v_and_b32 v165, s12, v210
    v_lshlrev_b32 v166, 16, v211
    v_and_b32 v167, s12, v211
    v_lshlrev_b32 v168, 16, v212
    v_and_b32 v169, s12, v212
    v_mul_f32 v64, v64, v152
    v_mul_f32 v65, v65, v153
    v_mul_f32 v66, v66, v154
    v_mul_f32 v67, v67, v155
    v_mul_f32 v68, v68, v156
    v_mul_f32 v69, v69, v157
    v_mul_f32 v70, v70, v158
    v_mul_f32 v71, v71, v159
    v_mul_f32 v72, v72, v160
    v_mul_f32 v73, v73, v161
    v_mul_f32 v74, v74, v162
    v_mul_f32 v75, v75, v163
    v_mul_f32 v76, v76, v164
    v_mul_f32 v77, v77, v165
    v_mul_f32 v78, v78, v166
    v_mul_f32 v79, v79, v167
    v_mul_f32 v80, v80, v168
    v_mul_f32 v81, v81, v169
    v_cvt_pk_bf16_f32 v84, v80, v78
    v_cvt_pk_bf16_f32 v85, v76, v74
    v_cvt_pk_bf16_f32 v86, v72, v70
    v_cvt_pk_bf16_f32 v87, v68, v66
    ds_write_b128 v240, v[84:87] offset:0
    v_cvt_pk_bf16_f32 v88, v78, v76
    v_cvt_pk_bf16_f32 v89, v74, v72
    v_cvt_pk_bf16_f32 v90, v70, v68
    v_cvt_pk_bf16_f32 v91, v66, v64
    ds_write_b128 v240, v[88:91] offset:16
    v_cvt_pk_bf16_f32 v92, v81, v79
    v_cvt_pk_bf16_f32 v93, v77, v75
    v_cvt_pk_bf16_f32 v94, v73, v71
    v_cvt_pk_bf16_f32 v95, v69, v67
    ds_write_b128 v240, v[92:95] offset:256
    v_cvt_pk_bf16_f32 v96, v79, v77
    v_cvt_pk_bf16_f32 v97, v75, v73
    v_cvt_pk_bf16_f32 v98, v71, v69
    v_cvt_pk_bf16_f32 v99, v67, v65
    ds_write_b128 v240, v[96:99] offset:272
    ds_read_b128 v[100:103], v241 offset:0
    ds_read_b128 v[104:107], v241 offset:1056
    ds_read_b128 v[108:111], v241 offset:2112
    ds_read_b128 v[112:115], v241 offset:3168
    s_mul_i32 s8, s4, 80
    s_lshl_b32 s9, s5, 4
    s_add_u32 s8, s8, s9
    s_lshl_b32 s8, s8, 13
    s_sub_u32 s9, 31, s3
    s_lshl_b32 s9, s9, 7
    s_add_u32 s8, s8, s9
    s_add_u32 s8, s8, 5505024
    s_waitcnt lgkmcnt(3)
    buffer_store_dwordx4 v[100:103], v242, s[44:47], s8 offen sc1
    s_add_u32 s8, s8, 32768
    s_waitcnt lgkmcnt(2)
    buffer_store_dwordx4 v[104:107], v242, s[44:47], s8 offen sc1
    s_add_u32 s8, s8, 32768
    s_waitcnt lgkmcnt(1)
    buffer_store_dwordx4 v[108:111], v242, s[44:47], s8 offen sc1
    s_add_u32 s8, s8, 32768
    s_waitcnt lgkmcnt(0)
    buffer_store_dwordx4 v[112:115], v242, s[44:47], s8 offen sc1
    s_cmp_lg_u32 s5, 3
    s_cbranch_scc1 L_25
    s_mov_b32 s10, 4
    ds_read_b32 v192, v243 offset:32
    ds_read_b32 v193, v243 offset:192
    ds_read_b32 v194, v243 offset:352
    ds_read_b32 v195, v243 offset:512
    ds_read_b32 v196, v243 offset:672
    ds_read_b32 v197, v243 offset:832
    ds_read_b32 v198, v243 offset:992
    ds_read_b32 v199, v243 offset:1152
    ds_read_b32 v200, v243 offset:1312
    ds_read_b32 v201, v243 offset:1472
    ds_read_b32 v202, v243 offset:1632
    ds_read_b32 v203, v243 offset:1792
    ds_read_b32 v204, v243 offset:16416
    ds_read_b32 v205, v243 offset:16576
    ds_read_b32 v206, v243 offset:16736
    ds_read_b32 v207, v243 offset:16896
    ds_read_b32 v208, v243 offset:17056
    ds_read_b32 v209, v243 offset:17216
    ds_read_b32 v210, v243 offset:17376
    ds_read_b32 v211, v243 offset:17536
    ds_read_b32 v212, v243 offset:17696
    v_lshlrev_b32 v170, 16, v220
    v_lshlrev_b32 v171, 16, v222
    v_and_b32 v172, s12, v220
    v_and_b32 v173, s12, v222
    v_lshlrev_b32 v174, 16, v221
    v_lshlrev_b32 v175, 16, v223
    v_and_b32 v176, s12, v221
    v_and_b32 v177, s12, v223
    s_waitcnt lgkmcnt(9)
    v_lshlrev_b32 v128, 16, v192
    v_and_b32 v129, s12, v192
    v_lshlrev_b32 v130, 16, v193
    v_and_b32 v131, s12, v193
    v_lshlrev_b32 v132, 16, v194
    v_and_b32 v133, s12, v194
    v_lshlrev_b32 v134, 16, v195
    v_and_b32 v135, s12, v195
    v_lshlrev_b32 v136, 16, v196
    v_and_b32 v137, s12, v196
    v_lshlrev_b32 v138, 16, v197
    v_and_b32 v139, s12, v197
    v_lshlrev_b32 v140, 16, v198
    v_and_b32 v141, s12, v198
    v_lshlrev_b32 v142, 16, v199
    v_and_b32 v143, s12, v199
    v_lshlrev_b32 v144, 16, v200
    v_and_b32 v145, s12, v200
    v_lshlrev_b32 v146, 16, v201
    v_and_b32 v147, s12, v201
    v_lshlrev_b32 v148, 16, v202
    v_and_b32 v149, s12, v202
    v_lshlrev_b32 v150, 16, v203
    v_and_b32 v151, s12, v203
    v_mul_f32 v64, v128, v176
    v_mul_f32 v65, v129, v177
    v_mul_f32 v66, v130, v176
    v_mul_f32 v67, v131, v177
    v_mul_f32 v68, v132, v176
    v_mul_f32 v69, v133, v177
    v_mul_f32 v70, v134, v176
    v_mul_f32 v71, v135, v177
    v_mul_f32 v72, v136, v176
    v_mul_f32 v73, v137, v177
    v_mul_f32 v74, v138, v176
    v_mul_f32 v75, v139, v177
    v_mul_f32 v76, v140, v176
    v_mul_f32 v77, v141, v177
    v_mul_f32 v78, v142, v176
    v_mul_f32 v79, v143, v177
    v_mul_f32 v80, v144, v176
    v_mul_f32 v81, v145, v177
    v_fmac_f32 v64, v130, v174
    v_fmac_f32 v65, v131, v175
    v_fmac_f32 v66, v132, v174
    v_fmac_f32 v67, v133, v175
    v_fmac_f32 v68, v134, v174
    v_fmac_f32 v69, v135, v175
    v_fmac_f32 v70, v136, v174
    v_fmac_f32 v71, v137, v175
    v_fmac_f32 v72, v138, v174
    v_fmac_f32 v73, v139, v175
    v_fmac_f32 v74, v140, v174
    v_fmac_f32 v75, v141, v175
    v_fmac_f32 v76, v142, v174
    v_fmac_f32 v77, v143, v175
    v_fmac_f32 v78, v144, v174
    v_fmac_f32 v79, v145, v175
    v_fmac_f32 v80, v146, v174
    v_fmac_f32 v81, v147, v175
    v_fmac_f32 v64, v132, v172
    v_fmac_f32 v65, v133, v173
    v_fmac_f32 v66, v134, v172
    v_fmac_f32 v67, v135, v173
    v_fmac_f32 v68, v136, v172
    v_fmac_f32 v69, v137, v173
    v_fmac_f32 v70, v138, v172
    v_fmac_f32 v71, v139, v173
    v_fmac_f32 v72, v140, v172
    v_fmac_f32 v73, v141, v173
    v_fmac_f32 v74, v142, v172
    v_fmac_f32 v75, v143, v173
    v_fmac_f32 v76, v144, v172
    v_fmac_f32 v77, v145, v173
    v_fmac_f32 v78, v146, v172
    v_fmac_f32 v79, v147, v173
    v_fmac_f32 v80, v148, v172
    v_fmac_f32 v81, v149, v173
    v_fmac_f32 v64, v134, v170
    v_fmac_f32 v65, v135, v171
    v_fmac_f32 v66, v136, v170
    v_fmac_f32 v67, v137, v171
    v_fmac_f32 v68, v138, v170
    v_fmac_f32 v69, v139, v171
    v_fmac_f32 v70, v140, v170
    v_fmac_f32 v71, v141, v171
    v_fmac_f32 v72, v142, v170
    v_fmac_f32 v73, v143, v171
    v_fmac_f32 v74, v144, v170
    v_fmac_f32 v75, v145, v171
    v_fmac_f32 v76, v146, v170
    v_fmac_f32 v77, v147, v171
    v_fmac_f32 v78, v148, v170
    v_fmac_f32 v79, v149, v171
    v_fmac_f32 v80, v150, v170
    v_fmac_f32 v81, v151, v171
    s_waitcnt lgkmcnt(0)
    v_lshlrev_b32 v152, 16, v204
    v_and_b32 v153, s12, v204
    v_lshlrev_b32 v154, 16, v205
    v_and_b32 v155, s12, v205
    v_lshlrev_b32 v156, 16, v206
    v_and_b32 v157, s12, v206
    v_lshlrev_b32 v158, 16, v207
    v_and_b32 v159, s12, v207
    v_lshlrev_b32 v160, 16, v208
    v_and_b32 v161, s12, v208
    v_lshlrev_b32 v162, 16, v209
    v_and_b32 v163, s12, v209
    v_lshlrev_b32 v164, 16, v210
    v_and_b32 v165, s12, v210
    v_lshlrev_b32 v166, 16, v211
    v_and_b32 v167, s12, v211
    v_lshlrev_b32 v168, 16, v212
    v_and_b32 v169, s12, v212
    v_mul_f32 v64, v64, v152
    v_mul_f32 v65, v65, v153
    v_mul_f32 v66, v66, v154
    v_mul_f32 v67, v67, v155
    v_mul_f32 v68, v68, v156
    v_mul_f32 v69, v69, v157
    v_mul_f32 v70, v70, v158
    v_mul_f32 v71, v71, v159
    v_mul_f32 v72, v72, v160
    v_mul_f32 v73, v73, v161
    v_mul_f32 v74, v74, v162
    v_mul_f32 v75, v75, v163
    v_mul_f32 v76, v76, v164
    v_mul_f32 v77, v77, v165
    v_mul_f32 v78, v78, v166
    v_mul_f32 v79, v79, v167
    v_mul_f32 v80, v80, v168
    v_mul_f32 v81, v81, v169
    v_cvt_pk_bf16_f32 v84, v80, v78
    v_cvt_pk_bf16_f32 v85, v76, v74
    v_cvt_pk_bf16_f32 v86, v72, v70
    v_cvt_pk_bf16_f32 v87, v68, v66
    ds_write_b128 v240, v[84:87] offset:0
    v_cvt_pk_bf16_f32 v88, v78, v76
    v_cvt_pk_bf16_f32 v89, v74, v72
    v_cvt_pk_bf16_f32 v90, v70, v68
    v_cvt_pk_bf16_f32 v91, v66, v64
    ds_write_b128 v240, v[88:91] offset:16
    v_cvt_pk_bf16_f32 v92, v81, v79
    v_cvt_pk_bf16_f32 v93, v77, v75
    v_cvt_pk_bf16_f32 v94, v73, v71
    v_cvt_pk_bf16_f32 v95, v69, v67
    ds_write_b128 v240, v[92:95] offset:256
    v_cvt_pk_bf16_f32 v96, v79, v77
    v_cvt_pk_bf16_f32 v97, v75, v73
    v_cvt_pk_bf16_f32 v98, v71, v69
    v_cvt_pk_bf16_f32 v99, v67, v65
    ds_write_b128 v240, v[96:99] offset:272
    ds_read_b128 v[100:103], v241 offset:0
    ds_read_b128 v[104:107], v241 offset:1056
    ds_read_b128 v[108:111], v241 offset:2112
    ds_read_b128 v[112:115], v241 offset:3168
    s_mul_i32 s8, s4, 80
    s_lshl_b32 s9, s10, 4
    s_add_u32 s8, s8, s9
    s_lshl_b32 s8, s8, 13
    s_sub_u32 s9, 31, s3
    s_lshl_b32 s9, s9, 7
    s_add_u32 s8, s8, s9
    s_add_u32 s8, s8, 5505024
    s_waitcnt lgkmcnt(3)
    buffer_store_dwordx4 v[100:103], v242, s[44:47], s8 offen sc1
    s_add_u32 s8, s8, 32768
    s_waitcnt lgkmcnt(2)
    buffer_store_dwordx4 v[104:107], v242, s[44:47], s8 offen sc1
    s_add_u32 s8, s8, 32768
    s_waitcnt lgkmcnt(1)
    buffer_store_dwordx4 v[108:111], v242, s[44:47], s8 offen sc1
    s_add_u32 s8, s8, 32768
    s_waitcnt lgkmcnt(0)
    buffer_store_dwordx4 v[112:115], v242, s[44:47], s8 offen sc1
    s_waitcnt vmcnt(0)
    s_mul_i32 s8, s4, 5
    s_add_u32 s8, s8, s10
    s_lshl_b32 s8, s8, 5
    s_add_u32 s8, s8, s3
    s_lshl_b32 s8, s8, 2
    s_add_u32 s8, s8, 4096
    v_mov_b32 v6, s78
    v_mov_b32 v7, 0
    s_mov_b64 exec, 1
    buffer_store_dword v6, v7, s[44:47], s8 offen sc1
    s_mov_b64 exec, -1
    s_mul_i32 s8, s4, 5
    s_add_u32 s8, s8, s5
    s_lshl_b32 s8, s8, 5
    s_add_u32 s8, s8, s3
    s_lshl_b32 s8, s8, 2
    s_add_u32 s8, s8, 4096
    v_mov_b32 v6, s78
    v_mov_b32 v7, 0
    s_mov_b64 exec, 1
    buffer_store_dword v6, v7, s[44:47], s8 offen sc1
    s_mov_b64 exec, -1
    s_setprio 0
    s_add_u32 s8, s65, 409600
    s_mov_b32 s9, 51200
L_28:
    s_add_u32 s10, s8, 0
    s_add_u32 m0, s9, 0
    s_nop 0
    buffer_load_dwordx4 v224, s[52:55], s10 offen lds
    s_add_u32 m0, s9, 1024
    s_nop 0
    buffer_load_dwordx4 v225, s[52:55], s10 offen lds
    s_add_u32 m0, s9, 2048
    s_nop 0
    buffer_load_dwordx4 v226, s[52:55], s10 offen lds
    s_add_u32 m0, s9, 3072
    s_nop 0
    buffer_load_dwordx4 v227, s[52:55], s10 offen lds
    s_add_u32 m0, s9, 4096
    s_nop 0
    buffer_load_dwordx4 v228, s[52:55], s10 offen lds
    s_waitcnt vmcnt(2)
    s_add_u32 s10, s8, 51200
    s_add_u32 m0, s9, 5120
    s_nop 0
    buffer_load_dwordx4 v224, s[52:55], s10 offen lds
    s_add_u32 m0, s9, 6144
    s_nop 0
    buffer_load_dwordx4 v225, s[52:55], s10 offen lds
    s_add_u32 m0, s9, 7168
    s_nop 0
    buffer_load_dwordx4 v226, s[52:55], s10 offen lds
    s_add_u32 m0, s9, 8192
    s_nop 0
    buffer_load_dwordx4 v227, s[52:55], s10 offen lds
    s_add_u32 m0, s9, 9216
    s_nop 0
    buffer_load_dwordx4 v228, s[52:55], s10 offen lds
    s_waitcnt vmcnt(2)
    s_add_u32 s10, s8, 102400
    s_add_u32 m0, s9, 10240
    s_nop 0
    buffer_load_dwordx4 v224, s[52:55], s10 offen lds
    s_add_u32 m0, s9, 11264
    s_nop 0
    buffer_load_dwordx4 v225, s[52:55], s10 offen lds
    s_add_u32 m0, s9, 12288
    s_nop 0
    buffer_load_dwordx4 v226, s[52:55], s10 offen lds
    s_add_u32 m0, s9, 13312
    s_nop 0
    buffer_load_dwordx4 v227, s[52:55], s10 offen lds
    s_add_u32 m0, s9, 14336
    s_nop 0
    buffer_load_dwordx4 v228, s[52:55], s10 offen lds
    s_waitcnt vmcnt(2)
    s_add_u32 s10, s8, 153600
    s_add_u32 m0, s9, 15360
    s_nop 0
    buffer_load_dwordx4 v224, s[52:55], s10 offen lds
    s_add_u32 m0, s9, 16384
    s_nop 0
    buffer_load_dwordx4 v225, s[52:55], s10 offen lds
    s_add_u32 m0, s9, 17408
    s_nop 0
    buffer_load_dwordx4 v226, s[52:55], s10 offen lds
    s_add_u32 m0, s9, 18432
    s_nop 0
    buffer_load_dwordx4 v227, s[52:55], s10 offen lds
    s_add_u32 m0, s9, 19456
    s_nop 0
    buffer_load_dwordx4 v228, s[52:55], s10 offen lds
    s_waitcnt vmcnt(2)
    s_add_u32 s10, s8, 0
    s_add_u32 m0, s9, 20480
    s_nop 0
    buffer_load_dwordx4 v229, s[52:55], s10 offen lds
    s_add_u32 m0, s9, 21504
    s_nop 0
    buffer_load_dwordx4 v230, s[52:55], s10 offen lds
    s_add_u32 m0, s9, 22528
    s_nop 0
    buffer_load_dwordx4 v231, s[52:55], s10 offen lds
    s_add_u32 m0, s9, 23552
    s_nop 0
    buffer_load_dwordx4 v232, s[52:55], s10 offen lds
    s_add_u32 m0, s9, 24576
    s_nop 0
    buffer_load_dwordx4 v233, s[52:55], s10 offen lds
    s_waitcnt vmcnt(2)
    s_add_u32 s8, s8, 204800
    s_add_u32 s9, s9, 25600
    s_cmp_lt_u32 s9, 102400
    s_cbranch_scc1 L_28
    s_mov_b32 s96, 131072
L_29:
    ds_read_b32 v4, v44 offset:4
    s_waitcnt lgkmcnt(0)
    v_cmp_ne_u32 s[8:9], 3, v4
    s_nop 0
    s_cmp_eq_u64 s[8:9], 0
    s_cbranch_scc1 L_30
    s_sleep 8
    s_sub_u32 s96, s96, 1
    s_cmp_lg_u32 s96, 0
    s_cbranch_scc1 L_29
L_30:
    s_add_u32 s8, s65, 0
    s_mov_b32 s9, 0
L_31:
    s_add_u32 s10, s8, 0
    s_add_u32 m0, s9, 0
    s_nop 0
    buffer_load_dwordx4 v224, s[52:55], s10 offen lds
    s_add_u32 m0, s9, 1024
    s_nop 0
    buffer_load_dwordx4 v225, s[52:55], s10 offen lds
    s_add_u32 m0, s9, 2048
    s_nop 0
    buffer_load_dwordx4 v226, s[52:55], s10 offen lds
    s_add_u32 m0, s9, 3072
    s_nop 0
    buffer_load_dwordx4 v227, s[52:55], s10 offen lds
    s_add_u32 m0, s9, 4096
    s_nop 0
    buffer_load_dwordx4 v228, s[52:55], s10 offen lds
    s_waitcnt vmcnt(2)
    s_add_u32 s10, s8, 51200
    s_add_u32 m0, s9, 5120
    s_nop 0
    buffer_load_dwordx4 v224, s[52:55], s10 offen lds
    s_add_u32 m0, s9, 6144
    s_nop 0
    buffer_load_dwordx4 v225, s[52:55], s10 offen lds
    s_add_u32 m0, s9, 7168
    s_nop 0
    buffer_load_dwordx4 v226, s[52:55], s10 offen lds
    s_add_u32 m0, s9, 8192
    s_nop 0
    buffer_load_dwordx4 v227, s[52:55], s10 offen lds
    s_add_u32 m0, s9, 9216
    s_nop 0
    buffer_load_dwordx4 v228, s[52:55], s10 offen lds
    s_waitcnt vmcnt(2)
    s_add_u32 s10, s8, 102400
    s_add_u32 m0, s9, 10240
    s_nop 0
    buffer_load_dwordx4 v224, s[52:55], s10 offen lds
    s_add_u32 m0, s9, 11264
    s_nop 0
    buffer_load_dwordx4 v225, s[52:55], s10 offen lds
    s_add_u32 m0, s9, 12288
    s_nop 0
    buffer_load_dwordx4 v226, s[52:55], s10 offen lds
    s_add_u32 m0, s9, 13312
    s_nop 0
    buffer_load_dwordx4 v227, s[52:55], s10 offen lds
    s_add_u32 m0, s9, 14336
    s_nop 0
    buffer_load_dwordx4 v228, s[52:55], s10 offen lds
    s_waitcnt vmcnt(2)
    s_add_u32 s10, s8, 153600
    s_add_u32 m0, s9, 15360
    s_nop 0
    buffer_load_dwordx4 v224, s[52:55], s10 offen lds
    s_add_u32 m0, s9, 16384
    s_nop 0
    buffer_load_dwordx4 v225, s[52:55], s10 offen lds
    s_add_u32 m0, s9, 17408
    s_nop 0
    buffer_load_dwordx4 v226, s[52:55], s10 offen lds
    s_add_u32 m0, s9, 18432
    s_nop 0
    buffer_load_dwordx4 v227, s[52:55], s10 offen lds
    s_add_u32 m0, s9, 19456
    s_nop 0
    buffer_load_dwordx4 v228, s[52:55], s10 offen lds
    s_waitcnt vmcnt(2)
    s_add_u32 s10, s8, 0
    s_add_u32 m0, s9, 20480
    s_nop 0
    buffer_load_dwordx4 v229, s[52:55], s10 offen lds
    s_add_u32 m0, s9, 21504
    s_nop 0
    buffer_load_dwordx4 v230, s[52:55], s10 offen lds
    s_add_u32 m0, s9, 22528
    s_nop 0
    buffer_load_dwordx4 v231, s[52:55], s10 offen lds
    s_add_u32 m0, s9, 23552
    s_nop 0
    buffer_load_dwordx4 v232, s[52:55], s10 offen lds
    s_add_u32 m0, s9, 24576
    s_nop 0
    buffer_load_dwordx4 v233, s[52:55], s10 offen lds
    s_waitcnt vmcnt(2)
    s_add_u32 s8, s8, 204800
    s_add_u32 s9, s9, 25600
    s_cmp_lt_u32 s9, 51200
    s_cbranch_scc1 L_31
    s_waitcnt vmcnt(0)
    v_mov_b32 v4, 1
    s_mov_b64 exec, 1
    ds_add_u32 v44, v4 offset:0
    s_mov_b64 exec, -1
    s_branch L_26
L_25:
    v_mov_b32 v4, 1
    s_mov_b64 exec, 1
    ds_add_u32 v44, v4 offset:4
    s_mov_b64 exec, -1
    s_lshl_b32 s12, s5, 8
    s_add_u32 s12, s12, s2
    s_min_u32 s13, s12, 639
    s_lshl_b32 s8, s13, 12
    s_add_u32 s48, s24, s8
    s_addc_u32 s49, s25, 0
    s_mov_b32 s50, 4096
    s_lshl_b32 s8, s13, 13
    s_add_u32 s8, s8, 5505024
    s_add_u32 s52, s42, s8
    s_addc_u32 s53, s43, 0
    s_mov_b32 s54, 4096
    s_add_u32 s56, s52, 4096
    s_addc_u32 s57, s53, 0
    s_mov_b32 s58, 4096
    s_load_dword s14, s[48:49], 0
    s_lshr_b32 s8, s13, 1
    s_lshl_b32 s8, s8, 2
    s_load_dword s15, s[26:27], s8
    s_mul_i32 s8, s13, 52429
    s_lshr_b32 s8, s8, 22
    s_mul_i32 s9, s8, 80
    s_sub_u32 s9, s13, s9
    s_lshr_b32 s9, s9, 4
    s_mul_i32 s8, s8, 5
    s_add_u32 s8, s8, s9
    s_lshl_b32 s13, s8, 7
    s_add_u32 s13, s13, 4096
    s_waitcnt vmcnt(0)
    s_mul_i32 s8, s4, 5
    s_add_u32 s8, s8, s5
    s_lshl_b32 s8, s8, 5
    s_add_u32 s8, s8, s3
    s_lshl_b32 s8, s8, 2
    s_add_u32 s8, s8, 4096
    v_mov_b32 v6, s78
    v_mov_b32 v7, 0
    s_mov_b64 exec, 1
    buffer_store_dword v6, v7, s[44:47], s8 offen sc1
    s_mov_b64 exec, -1
    s_waitcnt lgkmcnt(0)
    s_cmp_ge_u32 s12, 640
    s_cbranch_scc1 L_27
    s_mov_b32 m0, s68
    s_nop 0
    buffer_load_dwordx4 v235, s[48:51], 0 offen lds
    s_add_u32 m0, s68, 1024
    s_movk_i32 s8, 960
    buffer_load_dwordx4 v62, s[48:51], s8 offen offset:0 lds
    buffer_load_dwordx4 v62, s[48:51], s8 offen offset:1024 lds
    buffer_load_dwordx4 v62, s[48:51], s8 offen offset:2048 lds
    buffer_load_dwordx4 v62, s[48:51], s8 offen offset:3072 lds
    s_bitcmp1_b32 s12, 0
    s_cselect_b32 s8, 0, 16
    s_lshl_b32 s15, s15, s8
    s_and_b32 s15, s15, 0xffff0000
    s_lshl_b32 s8, s14, 16
    v_mov_b32 v5, s8
    v_add_f32 v5, s15, v5
    v_cvt_pk_bf16_f32 v5, v5, v5
    v_mov_b32 v6, s68
    s_waitcnt vmcnt(0)
    ds_write_b16 v6, v5 offset:64
    s_mov_b32 s96, 131072
L_32:
    ds_read_b32 v4, v44 offset:16
    s_waitcnt lgkmcnt(0)
    v_cmp_lt_u32 s[8:9], 7, v4
    s_nop 0
    s_cmp_eq_u64 s[8:9], 0
    s_cbranch_scc1 L_33
    s_sleep 8
    s_sub_u32 s96, s96, 1
    s_cmp_lg_u32 s96, 0
    s_cbranch_scc1 L_32
L_33:
    s_mov_b32 s96, 131072
L_34:
    buffer_load_dword v4, v236, s[44:47], s13 offen sc1
    s_waitcnt vmcnt(0)
    v_cmp_ne_u32 s[8:9], s78, v4
    s_nop 0
    s_cmp_eq_u64 s[8:9], 0
    s_cbranch_scc1 L_35
    s_sleep 24
    s_sub_u32 s96, s96, 1
    s_cmp_lg_u32 s96, 0
    s_cbranch_scc1 L_34
L_35:
    s_movk_i32 s8, 4096
    s_add_u32 m0, s68, 5120
    s_nop 0
    buffer_load_dwordx4 v62, s[52:55], 0 offen offset:0 sc1 lds
    buffer_load_dwordx4 v62, s[52:55], 0 offen offset:1024 sc1 lds
    buffer_load_dwordx4 v62, s[52:55], 0 offen offset:2048 sc1 lds
    buffer_load_dwordx4 v62, s[52:55], 0 offen offset:3072 sc1 lds
    s_add_u32 m0, s68, 9216
    s_nop 0
    buffer_load_dwordx4 v62, s[52:55], s8 offen sc1 lds
    s_add_u32 m0, s68, 10240
    s_nop 0
    buffer_load_dwordx4 v62, s[56:59], 0 offen offset:0 sc1 lds
    buffer_load_dwordx4 v62, s[56:59], 0 offen offset:1024 sc1 lds
    buffer_load_dwordx4 v62, s[56:59], 0 offen offset:2048 sc1 lds
    buffer_load_dwordx4 v62, s[56:59], 0 offen offset:3072 sc1 lds
    s_add_u32 m0, s68, 14336
    s_nop 0
    buffer_load_dwordx4 v62, s[56:59], s8 offen sc1 lds
    s_waitcnt vmcnt(0)
    s_setprio 0
    ds_read_b128 v[128:131], v232 offset:8704
    ds_read2_b32 v[96:97], v228 offset0:1 offset1:2
    ds_read2_b32 v[98:99], v228 offset0:3 offset1:4
    ds_read_b128 v[132:135], v232 offset:8192
    ds_read2_b32 v[100:101], v228 offset0:129 offset1:130
    ds_read2_b32 v[102:103], v228 offset0:131 offset1:132
    ds_read_b128 v[136:139], v232 offset:7680
    ds_read2_b32 v[104:105], v229 offset0:1 offset1:2
    ds_read2_b32 v[106:107], v229 offset0:3 offset1:4
    ds_read_b128 v[140:143], v232 offset:7168
    ds_read2_b32 v[108:109], v229 offset0:129 offset1:130
    ds_read2_b32 v[110:111], v229 offset0:131 offset1:132
    ds_read_b128 v[144:147], v232 offset:6656
    ds_read2_b32 v[112:113], v230 offset0:1 offset1:2
    ds_read2_b32 v[114:115], v230 offset0:3 offset1:4
    ds_read_b128 v[148:151], v232 offset:6144
    ds_read2_b32 v[116:117], v230 offset0:129 offset1:130
    ds_read2_b32 v[118:119], v230 offset0:131 offset1:132
    ds_read_b128 v[152:155], v232 offset:5632
    ds_read2_b32 v[120:121], v231 offset0:1 offset1:2
    ds_read2_b32 v[122:123], v231 offset0:3 offset1:4
    ds_read_b128 v[156:159], v232 offset:5120
    ds_read2_b32 v[124:125], v231 offset0:129 offset1:130
    ds_read2_b32 v[126:127], v231 offset0:131 offset1:132
    s_waitcnt lgkmcnt(0)
    v_mfma_f32_16x16x32_bf16 v[64:67], v[96:99], v[128:131], 0
    v_mfma_f32_16x16x32_bf16 v[68:71], v[96:99], v[132:135], 0
    v_mfma_f32_16x16x32_bf16 v[72:75], v[96:99], v[136:139], 0
    v_mfma_f32_16x16x32_bf16 v[76:79], v[96:99], v[140:143], 0
    ds_read_b128 v[192:195], v232 offset:8768
    ds_read2_b32 v[160:161], v228 offset0:17 offset1:18
    ds_read2_b32 v[162:163], v228 offset0:19 offset1:20
    v_mfma_f32_16x16x32_bf16 v[80:83], v[96:99], v[144:147], 0
    v_mfma_f32_16x16x32_bf16 v[84:87], v[96:99], v[148:151], 0
    v_mfma_f32_16x16x32_bf16 v[88:91], v[96:99], v[152:155], 0
    v_mfma_f32_16x16x32_bf16 v[92:95], v[96:99], v[156:159], 0
    ds_read_b128 v[196:199], v232 offset:8256
    ds_read2_b32 v[164:165], v228 offset0:145 offset1:146
    ds_read2_b32 v[166:167], v228 offset0:147 offset1:148
    v_mfma_f32_16x16x32_bf16 v[68:71], v[100:103], v[128:131], v[68:71]
    v_mfma_f32_16x16x32_bf16 v[72:75], v[100:103], v[132:135], v[72:75]
    v_mfma_f32_16x16x32_bf16 v[76:79], v[100:103], v[136:139], v[76:79]
    v_mfma_f32_16x16x32_bf16 v[80:83], v[100:103], v[140:143], v[80:83]
    ds_read_b128 v[200:203], v232 offset:7744
    ds_read2_b32 v[168:169], v229 offset0:17 offset1:18
    ds_read2_b32 v[170:171], v229 offset0:19 offset1:20
    v_mfma_f32_16x16x32_bf16 v[84:87], v[100:103], v[144:147], v[84:87]
    v_mfma_f32_16x16x32_bf16 v[88:91], v[100:103], v[148:151], v[88:91]
    v_mfma_f32_16x16x32_bf16 v[92:95], v[100:103], v[152:155], v[92:95]
    v_mfma_f32_16x16x32_bf16 v[72:75], v[104:107], v[128:131], v[72:75]
    ds_read_b128 v[204:207], v232 offset:7232
    ds_read2_b32 v[172:173], v229 offset0:145 offset1:146
    ds_read2_b32 v[174:175], v229 offset0:147 offset1:148
    v_mfma_f32_16x16x32_bf16 v[76:79], v[104:107], v[132:135], v[76:79]
    v_mfma_f32_16x16x32_bf16 v[80:83], v[104:107], v[136:139], v[80:83]
    v_mfma_f32_16x16x32_bf16 v[84:87], v[104:107], v[140:143], v[84:87]
    v_mfma_f32_16x16x32_bf16 v[88:91], v[104:107], v[144:147], v[88:91]
    ds_read_b128 v[208:211], v232 offset:6720
    ds_read2_b32 v[176:177], v230 offset0:17 offset1:18
    ds_read2_b32 v[178:179], v230 offset0:19 offset1:20
    v_mfma_f32_16x16x32_bf16 v[92:95], v[104:107], v[148:151], v[92:95]
    v_mfma_f32_16x16x32_bf16 v[76:79], v[108:111], v[128:131], v[76:79]
    v_mfma_f32_16x16x32_bf16 v[80:83], v[108:111], v[132:135], v[80:83]
    v_mfma_f32_16x16x32_bf16 v[84:87], v[108:111], v[136:139], v[84:87]
    ds_read_b128 v[212:215], v232 offset:6208
    ds_read2_b32 v[180:181], v230 offset0:145 offset1:146
    ds_read2_b32 v[182:183], v230 offset0:147 offset1:148
    v_mfma_f32_16x16x32_bf16 v[88:91], v[108:111], v[140:143], v[88:91]
    v_mfma_f32_16x16x32_bf16 v[92:95], v[108:111], v[144:147], v[92:95]
    v_mfma_f32_16x16x32_bf16 v[80:83], v[112:115], v[128:131], v[80:83]
    v_mfma_f32_16x16x32_bf16 v[84:87], v[112:115], v[132:135], v[84:87]
    ds_read_b128 v[216:219], v232 offset:5696
    ds_read2_b32 v[184:185], v231 offset0:17 offset1:18
    ds_read2_b32 v[186:187], v231 offset0:19 offset1:20
    v_mfma_f32_16x16x32_bf16 v[88:91], v[112:115], v[136:139], v[88:91]
    v_mfma_f32_16x16x32_bf16 v[92:95], v[112:115], v[140:143], v[92:95]
    v_mfma_f32_16x16x32_bf16 v[84:87], v[116:119], v[128:131], v[84:87]
    v_mfma_f32_16x16x32_bf16 v[88:91], v[116:119], v[132:135], v[88:91]
    ds_read_b128 v[220:223], v232 offset:5184
    ds_read2_b32 v[188:189], v231 offset0:145 offset1:146
    ds_read2_b32 v[190:191], v231 offset0:147 offset1:148
    v_mfma_f32_16x16x32_bf16 v[92:95], v[116:119], v[136:139], v[92:95]
    v_mfma_f32_16x16x32_bf16 v[88:91], v[120:123], v[128:131], v[88:91]
    v_mfma_f32_16x16x32_bf16 v[92:95], v[120:123], v[132:135], v[92:95]
    v_mfma_f32_16x16x32_bf16 v[92:95], v[124:127], v[128:131], v[92:95]
    s_waitcnt lgkmcnt(0)
    v_mfma_f32_16x16x32_bf16 v[64:67], v[160:163], v[192:195], v[64:67]
    v_mfma_f32_16x16x32_bf16 v[68:71], v[160:163], v[196:199], v[68:71]
    v_mfma_f32_16x16x32_bf16 v[72:75], v[160:163], v[200:203], v[72:75]
    v_mfma_f32_16x16x32_bf16 v[76:79], v[160:163], v[204:207], v[76:79]
    ds_read_b128 v[128:131], v232 offset:8832
    ds_read2_b32 v[96:97], v228 offset0:33 offset1:34
    ds_read2_b32 v[98:99], v228 offset0:35 offset1:36
    v_mfma_f32_16x16x32_bf16 v[80:83], v[160:163], v[208:211], v[80:83]
    v_mfma_f32_16x16x32_bf16 v[84:87], v[160:163], v[212:215], v[84:87]
    v_mfma_f32_16x16x32_bf16 v[88:91], v[160:163], v[216:219], v[88:91]
    v_mfma_f32_16x16x32_bf16 v[92:95], v[160:163], v[220:223], v[92:95]
    ds_read_b128 v[132:135], v232 offset:8320
    ds_read2_b32 v[100:101], v228 offset0:161 offset1:162
    ds_read2_b32 v[102:103], v228 offset0:163 offset1:164
    v_mfma_f32_16x16x32_bf16 v[68:71], v[164:167], v[192:195], v[68:71]
    v_mfma_f32_16x16x32_bf16 v[72:75], v[164:167], v[196:199], v[72:75]
    v_mfma_f32_16x16x32_bf16 v[76:79], v[164:167], v[200:203], v[76:79]
    v_mfma_f32_16x16x32_bf16 v[80:83], v[164:167], v[204:207], v[80:83]
    ds_read_b128 v[136:139], v232 offset:7808
    ds_read2_b32 v[104:105], v229 offset0:33 offset1:34
    ds_read2_b32 v[106:107], v229 offset0:35 offset1:36
    v_mfma_f32_16x16x32_bf16 v[84:87], v[164:167], v[208:211], v[84:87]
    v_mfma_f32_16x16x32_bf16 v[88:91], v[164:167], v[212:215], v[88:91]
    v_mfma_f32_16x16x32_bf16 v[92:95], v[164:167], v[216:219], v[92:95]
    v_mfma_f32_16x16x32_bf16 v[72:75], v[168:171], v[192:195], v[72:75]
    ds_read_b128 v[140:143], v232 offset:7296
    ds_read2_b32 v[108:109], v229 offset0:161 offset1:162
    ds_read2_b32 v[110:111], v229 offset0:163 offset1:164
    v_mfma_f32_16x16x32_bf16 v[76:79], v[168:171], v[196:199], v[76:79]
    v_mfma_f32_16x16x32_bf16 v[80:83], v[168:171], v[200:203], v[80:83]
    v_mfma_f32_16x16x32_bf16 v[84:87], v[168:171], v[204:207], v[84:87]
    v_mfma_f32_16x16x32_bf16 v[88:91], v[168:171], v[208:211], v[88:91]
    ds_read_b128 v[144:147], v232 offset:6784
    ds_read2_b32 v[112:113], v230 offset0:33 offset1:34
    ds_read2_b32 v[114:115], v230 offset0:35 offset1:36
    v_mfma_f32_16x16x32_bf16 v[92:95], v[168:171], v[212:215], v[92:95]
    v_mfma_f32_16x16x32_bf16 v[76:79], v[172:175], v[192:195], v[76:79]
    v_mfma_f32_16x16x32_bf16 v[80:83], v[172:175], v[196:199], v[80:83]
    v_mfma_f32_16x16x32_bf16 v[84:87], v[172:175], v[200:203], v[84:87]
    ds_read_b128 v[148:151], v232 offset:6272
    ds_read2_b32 v[116:117], v230 offset0:161 offset1:162
    ds_read2_b32 v[118:119], v230 offset0:163 offset1:164
    v_mfma_f32_16x16x32_bf16 v[88:91], v[172:175], v[204:207], v[88:91]
    v_mfma_f32_16x16x32_bf16 v[92:95], v[172:175], v[208:211], v[92:95]
    v_mfma_f32_16x16x32_bf16 v[80:83], v[176:179], v[192:195], v[80:83]
    v_mfma_f32_16x16x32_bf16 v[84:87], v[176:179], v[196:199], v[84:87]
    ds_read_b128 v[152:155], v232 offset:5760
    ds_read2_b32 v[120:121], v231 offset0:33 offset1:34
    ds_read2_b32 v[122:123], v231 offset0:35 offset1:36
    v_mfma_f32_16x16x32_bf16 v[88:91], v[176:179], v[200:203], v[88:91]
    v_mfma_f32_16x16x32_bf16 v[92:95], v[176:179], v[204:207], v[92:95]
    v_mfma_f32_16x16x32_bf16 v[84:87], v[180:183], v[192:195], v[84:87]
    v_mfma_f32_16x16x32_bf16 v[88:91], v[180:183], v[196:199], v[88:91]
    ds_read_b128 v[156:159], v232 offset:5248
    ds_read2_b32 v[124:125], v231 offset0:161 offset1:162
    ds_read2_b32 v[126:127], v231 offset0:163 offset1:164
    v_mfma_f32_16x16x32_bf16 v[92:95], v[180:183], v[200:203], v[92:95]
    v_mfma_f32_16x16x32_bf16 v[88:91], v[184:187], v[192:195], v[88:91]
    v_mfma_f32_16x16x32_bf16 v[92:95], v[184:187], v[196:199], v[92:95]
    v_mfma_f32_16x16x32_bf16 v[92:95], v[188:191], v[192:195], v[92:95]
    ds_read_b32 v4, v44 offset:16
    s_waitcnt lgkmcnt(0)
    v_readfirstlane_b32 s8, v4
    s_nop 0
    s_cmp_gt_u32 s8, 3
    s_cbranch_scc1 L_36
    s_setprio 2
L_36:
    v_mfma_f32_16x16x32_bf16 v[64:67], v[96:99], v[128:131], v[64:67]
    v_mfma_f32_16x16x32_bf16 v[68:71], v[96:99], v[132:135], v[68:71]
    v_mfma_f32_16x16x32_bf16 v[72:75], v[96:99], v[136:139], v[72:75]
    v_mfma_f32_16x16x32_bf16 v[76:79], v[96:99], v[140:143], v[76:79]
    ds_read_b128 v[192:195], v232 offset:8896
    ds_read2_b32 v[160:161], v228 offset0:49 offset1:50
    ds_read2_b32 v[162:163], v228 offset0:51 offset1:52
    v_mfma_f32_16x16x32_bf16 v[80:83], v[96:99], v[144:147], v[80:83]
    v_mfma_f32_16x16x32_bf16 v[84:87], v[96:99], v[148:151], v[84:87]
    v_mfma_f32_16x16x32_bf16 v[88:91], v[96:99], v[152:155], v[88:91]
    v_mfma_f32_16x16x32_bf16 v[92:95], v[96:99], v[156:159], v[92:95]
    ds_read_b128 v[196:199], v232 offset:8384
    ds_read2_b32 v[164:165], v228 offset0:177 offset1:178
    ds_read2_b32 v[166:167], v228 offset0:179 offset1:180
    v_mfma_f32_16x16x32_bf16 v[68:71], v[100:103], v[128:131], v[68:71]
    v_mfma_f32_16x16x32_bf16 v[72:75], v[100:103], v[132:135], v[72:75]
    v_mfma_f32_16x16x32_bf16 v[76:79], v[100:103], v[136:139], v[76:79]
    v_mfma_f32_16x16x32_bf16 v[80:83], v[100:103], v[140:143], v[80:83]
    ds_read_b128 v[200:203], v232 offset:7872
    ds_read2_b32 v[168:169], v229 offset0:49 offset1:50
    ds_read2_b32 v[170:171], v229 offset0:51 offset1:52
    v_mfma_f32_16x16x32_bf16 v[84:87], v[100:103], v[144:147], v[84:87]
    v_mfma_f32_16x16x32_bf16 v[88:91], v[100:103], v[148:151], v[88:91]
    v_mfma_f32_16x16x32_bf16 v[92:95], v[100:103], v[152:155], v[92:95]
    v_mfma_f32_16x16x32_bf16 v[72:75], v[104:107], v[128:131], v[72:75]
    ds_read_b128 v[204:207], v232 offset:7360
    ds_read2_b32 v[172:173], v229 offset0:177 offset1:178
    ds_read2_b32 v[174:175], v229 offset0:179 offset1:180
    v_mfma_f32_16x16x32_bf16 v[76:79], v[104:107], v[132:135], v[76:79]
    v_mfma_f32_16x16x32_bf16 v[80:83], v[104:107], v[136:139], v[80:83]
    v_mfma_f32_16x16x32_bf16 v[84:87], v[104:107], v[140:143], v[84:87]
    v_mfma_f32_16x16x32_bf16 v[88:91], v[104:107], v[144:147], v[88:91]
    ds_read_b128 v[208:211], v232 offset:6848
    ds_read2_b32 v[176:177], v230 offset0:49 offset1:50
    ds_read2_b32 v[178:179], v230 offset0:51 offset1:52
    v_mfma_f32_16x16x32_bf16 v[92:95], v[104:107], v[148:151], v[92:95]
    v_mfma_f32_16x16x32_bf16 v[76:79], v[108:111], v[128:131], v[76:79]
    v_mfma_f32_16x16x32_bf16 v[80:83], v[108:111], v[132:135], v[80:83]
    v_mfma_f32_16x16x32_bf16 v[84:87], v[108:111], v[136:139], v[84:87]
    ds_read_b128 v[212:215], v232 offset:6336
    ds_read2_b32 v[180:181], v230 offset0:177 offset1:178
    ds_read2_b32 v[182:183], v230 offset0:179 offset1:180
    v_mfma_f32_16x16x32_bf16 v[88:91], v[108:111], v[140:143], v[88:91]
    v_mfma_f32_16x16x32_bf16 v[92:95], v[108:111], v[144:147], v[92:95]
    v_mfma_f32_16x16x32_bf16 v[80:83], v[112:115], v[128:131], v[80:83]
    v_mfma_f32_16x16x32_bf16 v[84:87], v[112:115], v[132:135], v[84:87]
    ds_read_b128 v[216:219], v232 offset:5824
    ds_read2_b32 v[184:185], v231 offset0:49 offset1:50
    ds_read2_b32 v[186:187], v231 offset0:51 offset1:52
    v_mfma_f32_16x16x32_bf16 v[88:91], v[112:115], v[136:139], v[88:91]
    v_mfma_f32_16x16x32_bf16 v[92:95], v[112:115], v[140:143], v[92:95]
    v_mfma_f32_16x16x32_bf16 v[84:87], v[116:119], v[128:131], v[84:87]
    v_mfma_f32_16x16x32_bf16 v[88:91], v[116:119], v[132:135], v[88:91]
    ds_read_b128 v[220:223], v232 offset:5312
    ds_read2_b32 v[188:189], v231 offset0:177 offset1:178
    ds_read2_b32 v[190:191], v231 offset0:179 offset1:180
    v_mfma_f32_16x16x32_bf16 v[92:95], v[116:119], v[136:139], v[92:95]
    v_mfma_f32_16x16x32_bf16 v[88:91], v[120:123], v[128:131], v[88:91]
    v_mfma_f32_16x16x32_bf16 v[92:95], v[120:123], v[132:135], v[92:95]
    v_mfma_f32_16x16x32_bf16 v[92:95], v[124:127], v[128:131], v[92:95]
    ds_read_b32 v4, v44 offset:16
    s_waitcnt lgkmcnt(0)
    v_readfirstlane_b32 s8, v4
    s_nop 0
    s_cmp_gt_u32 s8, 3
    s_cbranch_scc1 L_37
    s_setprio 2
L_37:
    v_mfma_f32_16x16x32_bf16 v[64:67], v[160:163], v[192:195], v[64:67]
    v_mfma_f32_16x16x32_bf16 v[68:71], v[160:163], v[196:199], v[68:71]
    v_mfma_f32_16x16x32_bf16 v[72:75], v[160:163], v[200:203], v[72:75]
    v_mfma_f32_16x16x32_bf16 v[76:79], v[160:163], v[204:207], v[76:79]
    ds_read_b128 v[128:131], v232 offset:8960
    ds_read2_b32 v[96:97], v228 offset0:65 offset1:66
    ds_read2_b32 v[98:99], v228 offset0:67 offset1:68
    v_mfma_f32_16x16x32_bf16 v[80:83], v[160:163], v[208:211], v[80:83]
    v_mfma_f32_16x16x32_bf16 v[84:87], v[160:163], v[212:215], v[84:87]
    v_mfma_f32_16x16x32_bf16 v[88:91], v[160:163], v[216:219], v[88:91]
    v_mfma_f32_16x16x32_bf16 v[92:95], v[160:163], v[220:223], v[92:95]
    ds_read_b128 v[132:135], v232 offset:8448
    ds_read2_b32 v[100:101], v228 offset0:193 offset1:194
    ds_read2_b32 v[102:103], v228 offset0:195 offset1:196
    v_mfma_f32_16x16x32_bf16 v[68:71], v[164:167], v[192:195], v[68:71]
    v_mfma_f32_16x16x32_bf16 v[72:75], v[164:167], v[196:199], v[72:75]
    v_mfma_f32_16x16x32_bf16 v[76:79], v[164:167], v[200:203], v[76:79]
    v_mfma_f32_16x16x32_bf16 v[80:83], v[164:167], v[204:207], v[80:83]
    ds_read_b128 v[136:139], v232 offset:7936
    ds_read2_b32 v[104:105], v229 offset0:65 offset1:66
    ds_read2_b32 v[106:107], v229 offset0:67 offset1:68
    v_mfma_f32_16x16x32_bf16 v[84:87], v[164:167], v[208:211], v[84:87]
    v_mfma_f32_16x16x32_bf16 v[88:91], v[164:167], v[212:215], v[88:91]
    v_mfma_f32_16x16x32_bf16 v[92:95], v[164:167], v[216:219], v[92:95]
    v_mfma_f32_16x16x32_bf16 v[72:75], v[168:171], v[192:195], v[72:75]
    ds_read_b128 v[140:143], v232 offset:7424
    ds_read2_b32 v[108:109], v229 offset0:193 offset1:194
    ds_read2_b32 v[110:111], v229 offset0:195 offset1:196
    v_mfma_f32_16x16x32_bf16 v[76:79], v[168:171], v[196:199], v[76:79]
    v_mfma_f32_16x16x32_bf16 v[80:83], v[168:171], v[200:203], v[80:83]
    v_mfma_f32_16x16x32_bf16 v[84:87], v[168:171], v[204:207], v[84:87]
    v_mfma_f32_16x16x32_bf16 v[88:91], v[168:171], v[208:211], v[88:91]
    ds_read_b128 v[144:147], v232 offset:6912
    ds_read2_b32 v[112:113], v230 offset0:65 offset1:66
    ds_read2_b32 v[114:115], v230 offset0:67 offset1:68
    v_mfma_f32_16x16x32_bf16 v[92:95], v[168:171], v[212:215], v[92:95]
    v_mfma_f32_16x16x32_bf16 v[76:79], v[172:175], v[192:195], v[76:79]
    v_mfma_f32_16x16x32_bf16 v[80:83], v[172:175], v[196:199], v[80:83]
    v_mfma_f32_16x16x32_bf16 v[84:87], v[172:175], v[200:203], v[84:87]
    ds_read_b128 v[148:151], v232 offset:6400
    ds_read2_b32 v[116:117], v230 offset0:193 offset1:194
    ds_read2_b32 v[118:119], v230 offset0:195 offset1:196
    v_mfma_f32_16x16x32_bf16 v[88:91], v[172:175], v[204:207], v[88:91]
    v_mfma_f32_16x16x32_bf16 v[92:95], v[172:175], v[208:211], v[92:95]
    v_mfma_f32_16x16x32_bf16 v[80:83], v[176:179], v[192:195], v[80:83]
    v_mfma_f32_16x16x32_bf16 v[84:87], v[176:179], v[196:199], v[84:87]
    ds_read_b128 v[152:155], v232 offset:5888
    ds_read2_b32 v[120:121], v231 offset0:65 offset1:66
    ds_read2_b32 v[122:123], v231 offset0:67 offset1:68
    v_mfma_f32_16x16x32_bf16 v[88:91], v[176:179], v[200:203], v[88:91]
    v_mfma_f32_16x16x32_bf16 v[92:95], v[176:179], v[204:207], v[92:95]
    v_mfma_f32_16x16x32_bf16 v[84:87], v[180:183], v[192:195], v[84:87]
    v_mfma_f32_16x16x32_bf16 v[88:91], v[180:183], v[196:199], v[88:91]
    ds_read_b128 v[156:159], v232 offset:5376
    ds_read2_b32 v[124:125], v231 offset0:193 offset1:194
    ds_read2_b32 v[126:127], v231 offset0:195 offset1:196
    v_mfma_f32_16x16x32_bf16 v[92:95], v[180:183], v[200:203], v[92:95]
    v_mfma_f32_16x16x32_bf16 v[88:91], v[184:187], v[192:195], v[88:91]
    v_mfma_f32_16x16x32_bf16 v[92:95], v[184:187], v[196:199], v[92:95]
    v_mfma_f32_16x16x32_bf16 v[92:95], v[188:191], v[192:195], v[92:95]
    ds_read_b32 v4, v44 offset:16
    s_waitcnt lgkmcnt(0)
    v_readfirstlane_b32 s8, v4
    s_nop 0
    s_cmp_gt_u32 s8, 3
    s_cbranch_scc1 L_38
    s_setprio 2
L_38:
    v_mfma_f32_16x16x32_bf16 v[64:67], v[96:99], v[128:131], v[64:67]
    v_mfma_f32_16x16x32_bf16 v[68:71], v[96:99], v[132:135], v[68:71]
    v_mfma_f32_16x16x32_bf16 v[72:75], v[96:99], v[136:139], v[72:75]
    v_mfma_f32_16x16x32_bf16 v[76:79], v[96:99], v[140:143], v[76:79]
    ds_read_b128 v[192:195], v232 offset:9024
    ds_read2_b32 v[160:161], v228 offset0:81 offset1:82
    ds_read2_b32 v[162:163], v228 offset0:83 offset1:84
    v_mfma_f32_16x16x32_bf16 v[80:83], v[96:99], v[144:147], v[80:83]
    v_mfma_f32_16x16x32_bf16 v[84:87], v[96:99], v[148:151], v[84:87]
    v_mfma_f32_16x16x32_bf16 v[88:91], v[96:99], v[152:155], v[88:91]
    v_mfma_f32_16x16x32_bf16 v[92:95], v[96:99], v[156:159], v[92:95]
    ds_read_b128 v[196:199], v232 offset:8512
    ds_read2_b32 v[164:165], v228 offset0:209 offset1:210
    ds_read2_b32 v[166:167], v228 offset0:211 offset1:212
    v_mfma_f32_16x16x32_bf16 v[68:71], v[100:103], v[128:131], v[68:71]
    v_mfma_f32_16x16x32_bf16 v[72:75], v[100:103], v[132:135], v[72:75]
    v_mfma_f32_16x16x32_bf16 v[76:79], v[100:103], v[136:139], v[76:79]
    v_mfma_f32_16x16x32_bf16 v[80:83], v[100:103], v[140:143], v[80:83]
    ds_read_b128 v[200:203], v232 offset:8000
    ds_read2_b32 v[168:169], v229 offset0:81 offset1:82
    ds_read2_b32 v[170:171], v229 offset0:83 offset1:84
    v_mfma_f32_16x16x32_bf16 v[84:87], v[100:103], v[144:147], v[84:87]
    v_mfma_f32_16x16x32_bf16 v[88:91], v[100:103], v[148:151], v[88:91]
    v_mfma_f32_16x16x32_bf16 v[92:95], v[100:103], v[152:155], v[92:95]
    v_mfma_f32_16x16x32_bf16 v[72:75], v[104:107], v[128:131], v[72:75]
    ds_read_b128 v[204:207], v232 offset:7488
    ds_read2_b32 v[172:173], v229 offset0:209 offset1:210
    ds_read2_b32 v[174:175], v229 offset0:211 offset1:212
    v_mfma_f32_16x16x32_bf16 v[76:79], v[104:107], v[132:135], v[76:79]
    v_mfma_f32_16x16x32_bf16 v[80:83], v[104:107], v[136:139], v[80:83]
    v_mfma_f32_16x16x32_bf16 v[84:87], v[104:107], v[140:143], v[84:87]
    v_mfma_f32_16x16x32_bf16 v[88:91], v[104:107], v[144:147], v[88:91]
    ds_read_b128 v[208:211], v232 offset:6976
    ds_read2_b32 v[176:177], v230 offset0:81 offset1:82
    ds_read2_b32 v[178:179], v230 offset0:83 offset1:84
    v_mfma_f32_16x16x32_bf16 v[92:95], v[104:107], v[148:151], v[92:95]
    v_mfma_f32_16x16x32_bf16 v[76:79], v[108:111], v[128:131], v[76:79]
    v_mfma_f32_16x16x32_bf16 v[80:83], v[108:111], v[132:135], v[80:83]
    v_mfma_f32_16x16x32_bf16 v[84:87], v[108:111], v[136:139], v[84:87]
    ds_read_b128 v[212:215], v232 offset:6464
    ds_read2_b32 v[180:181], v230 offset0:209 offset1:210
    ds_read2_b32 v[182:183], v230 offset0:211 offset1:212
    v_mfma_f32_16x16x32_bf16 v[88:91], v[108:111], v[140:143], v[88:91]
    v_mfma_f32_16x16x32_bf16 v[92:95], v[108:111], v[144:147], v[92:95]
    v_mfma_f32_16x16x32_bf16 v[80:83], v[112:115], v[128:131], v[80:83]
    v_mfma_f32_16x16x32_bf16 v[84:87], v[112:115], v[132:135], v[84:87]
    ds_read_b128 v[216:219], v232 offset:5952
    ds_read2_b32 v[184:185], v231 offset0:81 offset1:82
    ds_read2_b32 v[186:187], v231 offset0:83 offset1:84
    v_mfma_f32_16x16x32_bf16 v[88:91], v[112:115], v[136:139], v[88:91]
    v_mfma_f32_16x16x32_bf16 v[92:95], v[112:115], v[140:143], v[92:95]
    v_mfma_f32_16x16x32_bf16 v[84:87], v[116:119], v[128:131], v[84:87]
    v_mfma_f32_16x16x32_bf16 v[88:91], v[116:119], v[132:135], v[88:91]
    ds_read_b128 v[220:223], v232 offset:5440
    ds_read2_b32 v[188:189], v231 offset0:209 offset1:210
    ds_read2_b32 v[190:191], v231 offset0:211 offset1:212
    v_mfma_f32_16x16x32_bf16 v[92:95], v[116:119], v[136:139], v[92:95]
    v_mfma_f32_16x16x32_bf16 v[88:91], v[120:123], v[128:131], v[88:91]
    v_mfma_f32_16x16x32_bf16 v[92:95], v[120:123], v[132:135], v[92:95]
    v_mfma_f32_16x16x32_bf16 v[92:95], v[124:127], v[128:131], v[92:95]
    ds_read_b32 v4, v44 offset:16
    s_waitcnt lgkmcnt(0)
    v_readfirstlane_b32 s8, v4
    s_nop 0
    s_cmp_gt_u32 s8, 3
    s_cbranch_scc1 L_39
    s_setprio 2
L_39:
    v_mfma_f32_16x16x32_bf16 v[64:67], v[160:163], v[192:195], v[64:67]
    v_mfma_f32_16x16x32_bf16 v[68:71], v[160:163], v[196:199], v[68:71]
    v_mfma_f32_16x16x32_bf16 v[72:75], v[160:163], v[200:203], v[72:75]
    v_mfma_f32_16x16x32_bf16 v[76:79], v[160:163], v[204:207], v[76:79]
    ds_read_b128 v[128:131], v232 offset:9088
    ds_read2_b32 v[96:97], v228 offset0:97 offset1:98
    ds_read2_b32 v[98:99], v228 offset0:99 offset1:100
    v_mfma_f32_16x16x32_bf16 v[80:83], v[160:163], v[208:211], v[80:83]
    v_mfma_f32_16x16x32_bf16 v[84:87], v[160:163], v[212:215], v[84:87]
    v_mfma_f32_16x16x32_bf16 v[88:91], v[160:163], v[216:219], v[88:91]
    v_mfma_f32_16x16x32_bf16 v[92:95], v[160:163], v[220:223], v[92:95]
    ds_read_b128 v[132:135], v232 offset:8576
    ds_read2_b32 v[100:101], v228 offset0:225 offset1:226
    ds_read2_b32 v[102:103], v228 offset0:227 offset1:228
    v_mfma_f32_16x16x32_bf16 v[68:71], v[164:167], v[192:195], v[68:71]
    v_mfma_f32_16x16x32_bf16 v[72:75], v[164:167], v[196:199], v[72:75]
    v_mfma_f32_16x16x32_bf16 v[76:79], v[164:167], v[200:203], v[76:79]
    v_mfma_f32_16x16x32_bf16 v[80:83], v[164:167], v[204:207], v[80:83]
    ds_read_b128 v[136:139], v232 offset:8064
    ds_read2_b32 v[104:105], v229 offset0:97 offset1:98
    ds_read2_b32 v[106:107], v229 offset0:99 offset1:100
    v_mfma_f32_16x16x32_bf16 v[84:87], v[164:167], v[208:211], v[84:87]
    v_mfma_f32_16x16x32_bf16 v[88:91], v[164:167], v[212:215], v[88:91]
    v_mfma_f32_16x16x32_bf16 v[92:95], v[164:167], v[216:219], v[92:95]
    v_mfma_f32_16x16x32_bf16 v[72:75], v[168:171], v[192:195], v[72:75]
    ds_read_b128 v[140:143], v232 offset:7552
    ds_read2_b32 v[108:109], v229 offset0:225 offset1:226
    ds_read2_b32 v[110:111], v229 offset0:227 offset1:228
    v_mfma_f32_16x16x32_bf16 v[76:79], v[168:171], v[196:199], v[76:79]
    v_mfma_f32_16x16x32_bf16 v[80:83], v[168:171], v[200:203], v[80:83]
    v_mfma_f32_16x16x32_bf16 v[84:87], v[168:171], v[204:207], v[84:87]
    v_mfma_f32_16x16x32_bf16 v[88:91], v[168:171], v[208:211], v[88:91]
    ds_read_b128 v[144:147], v232 offset:7040
    ds_read2_b32 v[112:113], v230 offset0:97 offset1:98
    ds_read2_b32 v[114:115], v230 offset0:99 offset1:100
    v_mfma_f32_16x16x32_bf16 v[92:95], v[168:171], v[212:215], v[92:95]
    v_mfma_f32_16x16x32_bf16 v[76:79], v[172:175], v[192:195], v[76:79]
    v_mfma_f32_16x16x32_bf16 v[80:83], v[172:175], v[196:199], v[80:83]
    v_mfma_f32_16x16x32_bf16 v[84:87], v[172:175], v[200:203], v[84:87]
    ds_read_b128 v[148:151], v232 offset:6528
    ds_read2_b32 v[116:117], v230 offset0:225 offset1:226
    ds_read2_b32 v[118:119], v230 offset0:227 offset1:228
    v_mfma_f32_16x16x32_bf16 v[88:91], v[172:175], v[204:207], v[88:91]
    v_mfma_f32_16x16x32_bf16 v[92:95], v[172:175], v[208:211], v[92:95]
    v_mfma_f32_16x16x32_bf16 v[80:83], v[176:179], v[192:195], v[80:83]
    v_mfma_f32_16x16x32_bf16 v[84:87], v[176:179], v[196:199], v[84:87]
    ds_read_b128 v[152:155], v232 offset:6016
    ds_read2_b32 v[120:121], v231 offset0:97 offset1:98
    ds_read2_b32 v[122:123], v231 offset0:99 offset1:100
    v_mfma_f32_16x16x32_bf16 v[88:91], v[176:179], v[200:203], v[88:91]
    v_mfma_f32_16x16x32_bf16 v[92:95], v[176:179], v[204:207], v[92:95]
    v_mfma_f32_16x16x32_bf16 v[84:87], v[180:183], v[192:195], v[84:87]
    v_mfma_f32_16x16x32_bf16 v[88:91], v[180:183], v[196:199], v[88:91]
    ds_read_b128 v[156:159], v232 offset:5504
    ds_read2_b32 v[124:125], v231 offset0:225 offset1:226
    ds_read2_b32 v[126:127], v231 offset0:227 offset1:228
    v_mfma_f32_16x16x32_bf16 v[92:95], v[180:183], v[200:203], v[92:95]
    v_mfma_f32_16x16x32_bf16 v[88:91], v[184:187], v[192:195], v[88:91]
    v_mfma_f32_16x16x32_bf16 v[92:95], v[184:187], v[196:199], v[92:95]
    v_mfma_f32_16x16x32_bf16 v[92:95], v[188:191], v[192:195], v[92:95]
    ds_read_b32 v4, v44 offset:16
    s_waitcnt lgkmcnt(0)
    v_readfirstlane_b32 s8, v4
    s_nop 0
    s_cmp_gt_u32 s8, 2
    s_cbranch_scc1 L_40
    s_setprio 2
L_40:
    v_mfma_f32_16x16x32_bf16 v[64:67], v[96:99], v[128:131], v[64:67]
    v_mfma_f32_16x16x32_bf16 v[68:71], v[96:99], v[132:135], v[68:71]
    v_mfma_f32_16x16x32_bf16 v[72:75], v[96:99], v[136:139], v[72:75]
    v_mfma_f32_16x16x32_bf16 v[76:79], v[96:99], v[140:143], v[76:79]
    ds_read_b128 v[192:195], v232 offset:9152
    ds_read2_b32 v[160:161], v228 offset0:113 offset1:114
    ds_read2_b32 v[162:163], v228 offset0:115 offset1:116
    v_mfma_f32_16x16x32_bf16 v[80:83], v[96:99], v[144:147], v[80:83]
    v_mfma_f32_16x16x32_bf16 v[84:87], v[96:99], v[148:151], v[84:87]
    v_mfma_f32_16x16x32_bf16 v[88:91], v[96:99], v[152:155], v[88:91]
    v_mfma_f32_16x16x32_bf16 v[92:95], v[96:99], v[156:159], v[92:95]
    ds_read_b128 v[196:199], v232 offset:8640
    ds_read2_b32 v[164:165], v228 offset0:241 offset1:242
    ds_read2_b32 v[166:167], v228 offset0:243 offset1:244
    v_mfma_f32_16x16x32_bf16 v[68:71], v[100:103], v[128:131], v[68:71]
    v_mfma_f32_16x16x32_bf16 v[72:75], v[100:103], v[132:135], v[72:75]
    v_mfma_f32_16x16x32_bf16 v[76:79], v[100:103], v[136:139], v[76:79]
    v_mfma_f32_16x16x32_bf16 v[80:83], v[100:103], v[140:143], v[80:83]
    ds_read_b128 v[200:203], v232 offset:8128
    ds_read2_b32 v[168:169], v229 offset0:113 offset1:114
    ds_read2_b32 v[170:171], v229 offset0:115 offset1:116
    v_mfma_f32_16x16x32_bf16 v[84:87], v[100:103], v[144:147], v[84:87]
    v_mfma_f32_16x16x32_bf16 v[88:91], v[100:103], v[148:151], v[88:91]
    v_mfma_f32_16x16x32_bf16 v[92:95], v[100:103], v[152:155], v[92:95]
    v_mfma_f32_16x16x32_bf16 v[72:75], v[104:107], v[128:131], v[72:75]
    ds_read_b128 v[204:207], v232 offset:7616
    ds_read2_b32 v[172:173], v229 offset0:241 offset1:242
    ds_read2_b32 v[174:175], v229 offset0:243 offset1:244
    v_mfma_f32_16x16x32_bf16 v[76:79], v[104:107], v[132:135], v[76:79]
    v_mfma_f32_16x16x32_bf16 v[80:83], v[104:107], v[136:139], v[80:83]
    v_mfma_f32_16x16x32_bf16 v[84:87], v[104:107], v[140:143], v[84:87]
    v_mfma_f32_16x16x32_bf16 v[88:91], v[104:107], v[144:147], v[88:91]
    ds_read_b128 v[208:211], v232 offset:7104
    ds_read2_b32 v[176:177], v230 offset0:113 offset1:114
    ds_read2_b32 v[178:179], v230 offset0:115 offset1:116
    v_mfma_f32_16x16x32_bf16 v[92:95], v[104:107], v[148:151], v[92:95]
    v_mfma_f32_16x16x32_bf16 v[76:79], v[108:111], v[128:131], v[76:79]
    v_mfma_f32_16x16x32_bf16 v[80:83], v[108:111], v[132:135], v[80:83]
    v_mfma_f32_16x16x32_bf16 v[84:87], v[108:111], v[136:139], v[84:87]
    ds_read_b128 v[212:215], v232 offset:6592
    ds_read2_b32 v[180:181], v230 offset0:241 offset1:242
    ds_read2_b32 v[182:183], v230 offset0:243 offset1:244
    v_mfma_f32_16x16x32_bf16 v[88:91], v[108:111], v[140:143], v[88:91]
    v_mfma_f32_16x16x32_bf16 v[92:95], v[108:111], v[144:147], v[92:95]
    v_mfma_f32_16x16x32_bf16 v[80:83], v[112:115], v[128:131], v[80:83]
    v_mfma_f32_16x16x32_bf16 v[84:87], v[112:115], v[132:135], v[84:87]
    ds_read_b128 v[216:219], v232 offset:6080
    ds_read2_b32 v[184:185], v231 offset0:113 offset1:114
    ds_read2_b32 v[186:187], v231 offset0:115 offset1:116
    v_mfma_f32_16x16x32_bf16 v[88:91], v[112:115], v[136:139], v[88:91]
    v_mfma_f32_16x16x32_bf16 v[92:95], v[112:115], v[140:143], v[92:95]
    v_mfma_f32_16x16x32_bf16 v[84:87], v[116:119], v[128:131], v[84:87]
    v_mfma_f32_16x16x32_bf16 v[88:91], v[116:119], v[132:135], v[88:91]
    ds_read_b128 v[220:223], v232 offset:5568
    ds_read2_b32 v[188:189], v231 offset0:241 offset1:242
    ds_read2_b32 v[190:191], v231 offset0:243 offset1:244
    v_mfma_f32_16x16x32_bf16 v[92:95], v[116:119], v[136:139], v[92:95]
    v_mfma_f32_16x16x32_bf16 v[88:91], v[120:123], v[128:131], v[88:91]
    v_mfma_f32_16x16x32_bf16 v[92:95], v[120:123], v[132:135], v[92:95]
    v_mfma_f32_16x16x32_bf16 v[92:95], v[124:127], v[128:131], v[92:95]
    ds_read_b32 v4, v44 offset:16
    s_waitcnt lgkmcnt(0)
    v_readfirstlane_b32 s8, v4
    s_nop 0
    s_cmp_gt_u32 s8, 2
    s_cbranch_scc1 L_41
    s_setprio 2
L_41:
    v_mfma_f32_16x16x32_bf16 v[64:67], v[160:163], v[192:195], v[64:67]
    v_mfma_f32_16x16x32_bf16 v[68:71], v[160:163], v[196:199], v[68:71]
    v_mfma_f32_16x16x32_bf16 v[72:75], v[160:163], v[200:203], v[72:75]
    v_mfma_f32_16x16x32_bf16 v[76:79], v[160:163], v[204:207], v[76:79]
    v_mfma_f32_16x16x32_bf16 v[80:83], v[160:163], v[208:211], v[80:83]
    v_mfma_f32_16x16x32_bf16 v[84:87], v[160:163], v[212:215], v[84:87]
    v_mfma_f32_16x16x32_bf16 v[88:91], v[160:163], v[216:219], v[88:91]
    v_mfma_f32_16x16x32_bf16 v[92:95], v[160:163], v[220:223], v[92:95]
    v_mfma_f32_16x16x32_bf16 v[68:71], v[164:167], v[192:195], v[68:71]
    v_mfma_f32_16x16x32_bf16 v[72:75], v[164:167], v[196:199], v[72:75]
    v_mfma_f32_16x16x32_bf16 v[76:79], v[164:167], v[200:203], v[76:79]
    v_mfma_f32_16x16x32_bf16 v[80:83], v[164:167], v[204:207], v[80:83]
    v_mfma_f32_16x16x32_bf16 v[84:87], v[164:167], v[208:211], v[84:87]
    v_mfma_f32_16x16x32_bf16 v[88:91], v[164:167], v[212:215], v[88:91]
    v_mfma_f32_16x16x32_bf16 v[92:95], v[164:167], v[216:219], v[92:95]
    v_mfma_f32_16x16x32_bf16 v[72:75], v[168:171], v[192:195], v[72:75]
    v_mfma_f32_16x16x32_bf16 v[76:79], v[168:171], v[196:199], v[76:79]
    v_mfma_f32_16x16x32_bf16 v[80:83], v[168:171], v[200:203], v[80:83]
    v_mfma_f32_16x16x32_bf16 v[84:87], v[168:171], v[204:207], v[84:87]
    v_mfma_f32_16x16x32_bf16 v[88:91], v[168:171], v[208:211], v[88:91]
    v_mfma_f32_16x16x32_bf16 v[92:95], v[168:171], v[212:215], v[92:95]
    v_mfma_f32_16x16x32_bf16 v[76:79], v[172:175], v[192:195], v[76:79]
    v_mfma_f32_16x16x32_bf16 v[80:83], v[172:175], v[196:199], v[80:83]
    v_mfma_f32_16x16x32_bf16 v[84:87], v[172:175], v[200:203], v[84:87]
    v_mfma_f32_16x16x32_bf16 v[88:91], v[172:175], v[204:207], v[88:91]
    v_mfma_f32_16x16x32_bf16 v[92:95], v[172:175], v[208:211], v[92:95]
    v_mfma_f32_16x16x32_bf16 v[80:83], v[176:179], v[192:195], v[80:83]
    v_mfma_f32_16x16x32_bf16 v[84:87], v[176:179], v[196:199], v[84:87]
    v_mfma_f32_16x16x32_bf16 v[88:91], v[176:179], v[200:203], v[88:91]
    v_mfma_f32_16x16x32_bf16 v[92:95], v[176:179], v[204:207], v[92:95]
    v_mfma_f32_16x16x32_bf16 v[84:87], v[180:183], v[192:195], v[84:87]
    v_mfma_f32_16x16x32_bf16 v[88:91], v[180:183], v[196:199], v[88:91]
    v_mfma_f32_16x16x32_bf16 v[92:95], v[180:183], v[200:203], v[92:95]
    v_mfma_f32_16x16x32_bf16 v[88:91], v[184:187], v[192:195], v[88:91]
    v_mfma_f32_16x16x32_bf16 v[92:95], v[184:187], v[196:199], v[92:95]
    v_mfma_f32_16x16x32_bf16 v[92:95], v[188:191], v[192:195], v[92:95]
    s_setprio 2
    s_lshl_b32 s8, s12, 12
    s_add_u32 s8, s8, 2883584
    v_cvt_pk_bf16_f32 v96, v64, v65
    v_cvt_pk_bf16_f32 v97, v66, v67
    v_cvt_pk_bf16_f32 v98, v68, v69
    v_cvt_pk_bf16_f32 v99, v70, v71
    s_nop 0
    v_permlane32_swap_b32 v96, v98
    v_permlane32_swap_b32 v97, v99
    buffer_store_dwordx4 v[96:99], v234, s[44:47], s8 offen offset:0 sc1
    v_cvt_pk_bf16_f32 v100, v72, v73
    v_cvt_pk_bf16_f32 v101, v74, v75
    v_cvt_pk_bf16_f32 v102, v76, v77
    v_cvt_pk_bf16_f32 v103, v78, v79
    s_nop 0
    v_permlane32_swap_b32 v100, v102
    v_permlane32_swap_b32 v101, v103
    buffer_store_dwordx4 v[100:103], v234, s[44:47], s8 offen offset:1024 sc1
    v_cvt_pk_bf16_f32 v104, v80, v81
    v_cvt_pk_bf16_f32 v105, v82, v83
    v_cvt_pk_bf16_f32 v106, v84, v85
    v_cvt_pk_bf16_f32 v107, v86, v87
    s_nop 0
    v_permlane32_swap_b32 v104, v106
    v_permlane32_swap_b32 v105, v107
    buffer_store_dwordx4 v[104:107], v234, s[44:47], s8 offen offset:2048 sc1
    v_cvt_pk_bf16_f32 v108, v88, v89
    v_cvt_pk_bf16_f32 v109, v90, v91
    v_cvt_pk_bf16_f32 v110, v92, v93
    v_cvt_pk_bf16_f32 v111, v94, v95
    s_nop 0
    v_permlane32_swap_b32 v108, v110
    v_permlane32_swap_b32 v109, v111
    buffer_store_dwordx4 v[108:111], v234, s[44:47], s8 offen offset:3072 sc1
    s_lshl_b32 s8, s12, 2
    s_add_u32 s8, s8, 12288
    s_waitcnt vmcnt(0)
    v_mov_b32 v6, s78
    v_mov_b32 v7, 0
    s_mov_b64 exec, 1
    buffer_store_dword v6, v7, s[44:47], s8 offen sc1
    s_mov_b64 exec, -1
L_27:
    v_mov_b32 v4, 1
    s_mov_b64 exec, 1
    ds_add_u32 v44, v4 offset:8
    s_mov_b64 exec, -1
L_26:
    s_setprio 2
    s_mov_b32 s48, s16
    s_mov_b32 s49, s17
    s_mov_b32 s50, 2621440
    s_mov_b32 s51, 0x20000
    s_mov_b32 exec_lo, -1
    s_mov_b32 exec_hi, 0xff
    s_movk_i32 s8, 0
    buffer_load_dwordx2 v[8:9], v48, s[48:51], s8 offen
    s_movk_i32 s8, 2560
    buffer_load_dwordx2 v[10:11], v48, s[48:51], s8 offen
    s_movk_i32 s8, 5120
    buffer_load_dwordx2 v[12:13], v48, s[48:51], s8 offen
    s_movk_i32 s8, 7680
    buffer_load_dwordx2 v[14:15], v48, s[48:51], s8 offen
    s_movk_i32 s8, 20480
    buffer_load_dwordx2 v[16:17], v48, s[48:51], s8 offen
    s_movk_i32 s8, 23040
    buffer_load_dwordx2 v[18:19], v48, s[48:51], s8 offen
    s_movk_i32 s8, 25600
    buffer_load_dwordx2 v[20:21], v48, s[48:51], s8 offen
    s_movk_i32 s8, 28160
    buffer_load_dwordx2 v[22:23], v48, s[48:51], s8 offen
    s_mov_b64 exec, -1
    buffer_load_dwordx4 v[64:67], v58, s[44:47], s72 offen sc1
    buffer_load_dwordx4 v[64:67], v58, s[44:47], s72 offen offset:1024 sc1
    buffer_load_dwordx2 v[64:65], v59, s[44:47], s73 offen sc1
    buffer_load_dwordx2 v[64:65], v59, s[44:47], s73 offen offset:256 sc1
    v_mov_b32 v4, 0
    buffer_load_dword v64, v4, s[44:47], s74 offen sc1
    s_mov_b32 s96, 131072
L_42:
    ds_read_b32 v4, v44 offset:0
    s_waitcnt lgkmcnt(0)
    v_cmp_ne_u32 s[8:9], 2, v4
    s_nop 0
    s_cmp_eq_u64 s[8:9], 0
    s_cbranch_scc1 L_43
    s_sleep 16
    s_sub_u32 s96, s96, 1
    s_cmp_lg_u32 s96, 0
    s_cbranch_scc1 L_42
L_43:
    ds_read_b64_tr_b16 v[96:97], v52 offset:0
    ds_read_b64_tr_b16 v[98:99], v53 offset:0
    ds_read_b64_tr_b16 v[100:101], v52 offset:32
    ds_read_b64_tr_b16 v[102:103], v53 offset:32
    ds_read_b64_tr_b16 v[104:105], v52 offset:64
    ds_read_b64_tr_b16 v[106:107], v53 offset:64
    ds_read_b64_tr_b16 v[108:109], v52 offset:96
    ds_read_b64_tr_b16 v[110:111], v53 offset:96
    ds_read_b64_tr_b16 v[112:113], v52 offset:128
    ds_read_b64_tr_b16 v[114:115], v53 offset:128
    ds_read_b64_tr_b16 v[116:117], v52 offset:5120
    ds_read_b64_tr_b16 v[118:119], v53 offset:5120
    ds_read_b64_tr_b16 v[120:121], v52 offset:5152
    ds_read_b64_tr_b16 v[122:123], v53 offset:5152
    ds_read_b64_tr_b16 v[124:125], v52 offset:5184
    ds_read_b64_tr_b16 v[126:127], v53 offset:5184
    ds_read_b64_tr_b16 v[128:129], v52 offset:5216
    ds_read_b64_tr_b16 v[130:131], v53 offset:5216
    ds_read_b64_tr_b16 v[132:133], v52 offset:5248
    ds_read_b64_tr_b16 v[134:135], v53 offset:5248
    ds_read_b64_tr_b16 v[136:137], v52 offset:10240
    ds_read_b64_tr_b16 v[138:139], v53 offset:10240
    ds_read_b64_tr_b16 v[140:141], v52 offset:10272
    ds_read_b64_tr_b16 v[142:143], v53 offset:10272
    ds_read_b64_tr_b16 v[144:145], v52 offset:10304
    ds_read_b64_tr_b16 v[146:147], v53 offset:10304
    ds_read_b64_tr_b16 v[148:149], v52 offset:10336
    ds_read_b64_tr_b16 v[150:151], v53 offset:10336
    ds_read_b64_tr_b16 v[152:153], v52 offset:10368
    ds_read_b64_tr_b16 v[154:155], v53 offset:10368
    ds_read_b64_tr_b16 v[156:157], v52 offset:15360
    ds_read_b64_tr_b16 v[158:159], v53 offset:15360
    ds_read_b64_tr_b16 v[160:161], v52 offset:15392
    ds_read_b64_tr_b16 v[162:163], v53 offset:15392
    ds_read_b64_tr_b16 v[164:165], v52 offset:15424
    ds_read_b64_tr_b16 v[166:167], v53 offset:15424
    ds_read_b64_tr_b16 v[168:169], v52 offset:15456
    ds_read_b64_tr_b16 v[170:171], v53 offset:15456
    ds_read_b64_tr_b16 v[172:173], v52 offset:15488
    ds_read_b64_tr_b16 v[174:175], v53 offset:15488
    ds_read_b64_tr_b16 v[176:177], v52 offset:20480
    ds_read_b64_tr_b16 v[178:179], v53 offset:20480
    ds_read_b64_tr_b16 v[180:181], v52 offset:20512
    ds_read_b64_tr_b16 v[182:183], v53 offset:20512
    ds_read_b64_tr_b16 v[184:185], v52 offset:20544
    ds_read_b64_tr_b16 v[186:187], v53 offset:20544
    ds_read_b64_tr_b16 v[188:189], v52 offset:20576
    ds_read_b64_tr_b16 v[190:191], v53 offset:20576
    ds_read_b64_tr_b16 v[192:193], v52 offset:20608
    ds_read_b64_tr_b16 v[194:195], v53 offset:20608
    ds_read_b64_tr_b16 v[196:197], v52 offset:25600
    ds_read_b64_tr_b16 v[198:199], v53 offset:25600
    ds_read_b64_tr_b16 v[200:201], v52 offset:25632
    ds_read_b64_tr_b16 v[202:203], v53 offset:25632
    ds_read_b64_tr_b16 v[204:205], v52 offset:25664
    ds_read_b64_tr_b16 v[206:207], v53 offset:25664
    ds_read_b64_tr_b16 v[208:209], v52 offset:25696
    ds_read_b64_tr_b16 v[210:211], v53 offset:25696
    ds_read_b64_tr_b16 v[212:213], v52 offset:25728
    ds_read_b64_tr_b16 v[214:215], v53 offset:25728
    ds_read_b64_tr_b16 v[216:217], v52 offset:30720
    ds_read_b64_tr_b16 v[218:219], v53 offset:30720
    ds_read_b64_tr_b16 v[220:221], v52 offset:30752
    ds_read_b64_tr_b16 v[222:223], v53 offset:30752
    ds_read_b64_tr_b16 v[224:225], v52 offset:30784
    ds_read_b64_tr_b16 v[226:227], v53 offset:30784
    ds_read_b64_tr_b16 v[228:229], v52 offset:30816
    ds_read_b64_tr_b16 v[230:231], v53 offset:30816
    ds_read_b64_tr_b16 v[232:233], v52 offset:30848
    ds_read_b64_tr_b16 v[234:235], v53 offset:30848
    ds_read_b64_tr_b16 v[236:237], v52 offset:35840
    ds_read_b64_tr_b16 v[238:239], v53 offset:35840
    ds_read_b64_tr_b16 v[240:241], v52 offset:35872
    ds_read_b64_tr_b16 v[242:243], v53 offset:35872
    ds_read_b64_tr_b16 v[244:245], v52 offset:35904
    ds_read_b64_tr_b16 v[246:247], v53 offset:35904
    ds_read_b64_tr_b16 v[248:249], v52 offset:35936
    ds_read_b64_tr_b16 v[250:251], v53 offset:35936
    ds_read_b64_tr_b16 v[252:253], v52 offset:35968
    ds_read_b64_tr_b16 v[254:255], v53 offset:35968
    s_mov_b32 s56, s38
    s_mov_b32 s57, s39
    s_mov_b32 s58, 5242880
    s_mov_b32 s59, 0x20000
    s_mov_b32 s70, 0
    s_mov_b32 s96, 131072
L_44:
    ds_read_b32 v4, v44 offset:16
    s_waitcnt lgkmcnt(0)
    v_cmp_lt_u32 s[8:9], 1, v4
    s_nop 0
    s_cmp_eq_u64 s[8:9], 0
    s_cbranch_scc1 L_45
    s_sleep 8
    s_sub_u32 s96, s96, 1
    s_cmp_lg_u32 s96, 0
    s_cbranch_scc1 L_44
L_45:
    s_setprio 2
L_46:
    s_sleep 16
    s_lshl_b32 s11, s3, 7
    s_lshl_b32 s8, s5, 5
    s_add_u32 s11, s11, s8
    s_add_u32 s11, s11, 2883584
    s_mov_b32 s14, 12288
    s_mov_b32 exec_lo, -1
    s_mov_b32 exec_hi, 0xff
    s_mov_b32 s96, 131072
L_49:
    buffer_load_dwordx4 v[40:43], v50, s[44:47], s14 offen sc1
    s_waitcnt vmcnt(0)
    v_cmp_ne_u32 s[8:9], s78, v40
    v_cmp_ne_u32 vcc, s78, v41
    s_nop 0
    s_or_b64 s[8:9], s[8:9], vcc
    v_cmp_ne_u32 vcc, s78, v42
    s_nop 0
    s_or_b64 s[8:9], s[8:9], vcc
    v_cmp_ne_u32 vcc, s78, v43
    s_nop 0
    s_or_b64 s[8:9], s[8:9], vcc
    s_cmp_eq_u64 s[8:9], 0
    s_cbranch_scc0 L_48
    buffer_load_dwordx4 v[24:27], v51, s[44:47], s11 offen sc1
    s_add_u32 s11, s11, 4096
    buffer_load_dwordx4 v[28:31], v51, s[44:47], s11 offen sc1
    s_add_u32 s11, s11, 4096
    buffer_load_dwordx4 v[32:35], v51, s[44:47], s11 offen sc1
    s_add_u32 s11, s11, 4096
    buffer_load_dwordx4 v[36:39], v51, s[44:47], s11 offen sc1
    s_mov_b32 s70, 1
    s_mov_b32 s14, 0xffff0000
    s_waitcnt vmcnt(0)
    v_lshlrev_b32 v64, 16, v8
    v_lshlrev_b32 v68, 16, v24
    v_and_b32 v65, s14, v8
    v_lshlrev_b32 v69, 16, v28
    v_lshlrev_b32 v66, 16, v9
    v_lshlrev_b32 v70, 16, v32
    v_and_b32 v67, s14, v9
    v_lshlrev_b32 v71, 16, v36
    v_mul_f32 v64, v64, v68
    v_mul_f32 v65, v65, v69
    v_mul_f32 v66, v66, v70
    v_mul_f32 v67, v67, v71
    v_cvt_pk_bf16_f32 v8, v64, v65
    v_cvt_pk_bf16_f32 v9, v66, v67
    s_mov_b32 s8, 0
    buffer_store_dwordx2 v[8:9], v49, s[56:59], s8 offen nt
    v_lshlrev_b32 v64, 16, v10
    v_and_b32 v68, s14, v24
    v_and_b32 v65, s14, v10
    v_and_b32 v69, s14, v28
    v_lshlrev_b32 v66, 16, v11
    v_and_b32 v70, s14, v32
    v_and_b32 v67, s14, v11
    v_and_b32 v71, s14, v36
    v_mul_f32 v64, v64, v68
    v_mul_f32 v65, v65, v69
    v_mul_f32 v66, v66, v70
    v_mul_f32 v67, v67, v71
    v_cvt_pk_bf16_f32 v10, v64, v65
    v_cvt_pk_bf16_f32 v11, v66, v67
    s_mov_b32 s8, 5120
    buffer_store_dwordx2 v[10:11], v49, s[56:59], s8 offen nt
    v_lshlrev_b32 v64, 16, v12
    v_lshlrev_b32 v68, 16, v25
    v_and_b32 v65, s14, v12
    v_lshlrev_b32 v69, 16, v29
    v_lshlrev_b32 v66, 16, v13
    v_lshlrev_b32 v70, 16, v33
    v_and_b32 v67, s14, v13
    v_lshlrev_b32 v71, 16, v37
    v_mul_f32 v64, v64, v68
    v_mul_f32 v65, v65, v69
    v_mul_f32 v66, v66, v70
    v_mul_f32 v67, v67, v71
    v_cvt_pk_bf16_f32 v12, v64, v65
    v_cvt_pk_bf16_f32 v13, v66, v67
    s_mov_b32 s8, 10240
    buffer_store_dwordx2 v[12:13], v49, s[56:59], s8 offen nt
    v_lshlrev_b32 v64, 16, v14
    v_and_b32 v68, s14, v25
    v_and_b32 v65, s14, v14
    v_and_b32 v69, s14, v29
    v_lshlrev_b32 v66, 16, v15
    v_and_b32 v70, s14, v33
    v_and_b32 v67, s14, v15
    v_and_b32 v71, s14, v37
    v_mul_f32 v64, v64, v68
    v_mul_f32 v65, v65, v69
    v_mul_f32 v66, v66, v70
    v_mul_f32 v67, v67, v71
    v_cvt_pk_bf16_f32 v14, v64, v65
    v_cvt_pk_bf16_f32 v15, v66, v67
    s_mov_b32 s8, 15360
    buffer_store_dwordx2 v[14:15], v49, s[56:59], s8 offen nt
    v_lshlrev_b32 v64, 16, v16
    v_lshlrev_b32 v68, 16, v26
    v_and_b32 v65, s14, v16
    v_lshlrev_b32 v69, 16, v30
    v_lshlrev_b32 v66, 16, v17
    v_lshlrev_b32 v70, 16, v34
    v_and_b32 v67, s14, v17
    v_lshlrev_b32 v71, 16, v38
    v_mul_f32 v64, v64, v68
    v_mul_f32 v65, v65, v69
    v_mul_f32 v66, v66, v70
    v_mul_f32 v67, v67, v71
    v_cvt_pk_bf16_f32 v16, v64, v65
    v_cvt_pk_bf16_f32 v17, v66, v67
    s_mov_b32 s8, 40960
    buffer_store_dwordx2 v[16:17], v49, s[56:59], s8 offen nt
    v_lshlrev_b32 v64, 16, v18
    v_and_b32 v68, s14, v26
    v_and_b32 v65, s14, v18
    v_and_b32 v69, s14, v30
    v_lshlrev_b32 v66, 16, v19
    v_and_b32 v70, s14, v34
    v_and_b32 v67, s14, v19
    v_and_b32 v71, s14, v38
    v_mul_f32 v64, v64, v68
    v_mul_f32 v65, v65, v69
    v_mul_f32 v66, v66, v70
    v_mul_f32 v67, v67, v71
    v_cvt_pk_bf16_f32 v18, v64, v65
    v_cvt_pk_bf16_f32 v19, v66, v67
    s_mov_b32 s8, 46080
    buffer_store_dwordx2 v[18:19], v49, s[56:59], s8 offen nt
    v_lshlrev_b32 v64, 16, v20
    v_lshlrev_b32 v68, 16, v27
    v_and_b32 v65, s14, v20
    v_lshlrev_b32 v69, 16, v31
    v_lshlrev_b32 v66, 16, v21
    v_lshlrev_b32 v70, 16, v35
    v_and_b32 v67, s14, v21
    v_lshlrev_b32 v71, 16, v39
    v_mul_f32 v64, v64, v68
    v_mul_f32 v65, v65, v69
    v_mul_f32 v66, v66, v70
    v_mul_f32 v67, v67, v71
    v_cvt_pk_bf16_f32 v20, v64, v65
    v_cvt_pk_bf16_f32 v21, v66, v67
    s_mov_b32 s8, 51200
    buffer_store_dwordx2 v[20:21], v49, s[56:59], s8 offen nt
    v_lshlrev_b32 v64, 16, v22
    v_and_b32 v68, s14, v27
    v_and_b32 v65, s14, v22
    v_and_b32 v69, s14, v31
    v_lshlrev_b32 v66, 16, v23
    v_and_b32 v70, s14, v35
    v_and_b32 v67, s14, v23
    v_and_b32 v71, s14, v39
    v_mul_f32 v64, v64, v68
    v_mul_f32 v65, v65, v69
    v_mul_f32 v66, v66, v70
    v_mul_f32 v67, v67, v71
    v_cvt_pk_bf16_f32 v22, v64, v65
    v_cvt_pk_bf16_f32 v23, v66, v67
    s_mov_b32 s8, 56320
    buffer_store_dwordx2 v[22:23], v49, s[56:59], s8 offen nt
L_48:
    s_mov_b64 exec, -1
    s_cmp_eq_u32 s70, 1
    s_cbranch_scc1 L_47
    ds_read_b32 v4, v44 offset:16
    s_waitcnt lgkmcnt(0)
    v_readfirstlane_b32 s8, v4
    s_nop 0
    s_cmp_lg_u32 s8, 0
    s_cbranch_scc1 L_46
L_47:
L_18:
    v_add_u32 v84, 0, v0
    v_mul_u32_u24 v85, 6554, v84
    v_lshrrev_b32 v85, 16, v85
    v_mul_u32_u24 v86, 10, v85
    v_sub_u32 v86, v84, v86
    v_mul_u32_u24 v94, 336, v85
    v_lshl_add_u32 v94, v86, 5, v94
    v_add_u32 v94, 102400, v94
    v_mul_u32_u24 v60, 2560, v85
    v_lshl_add_u32 v60, v86, 4, v60
    v_add_u32 v84, 512, v0
    v_mul_u32_u24 v85, 6554, v84
    v_lshrrev_b32 v85, 16, v85
    v_mul_u32_u24 v86, 10, v85
    v_sub_u32 v86, v84, v86
    v_mul_u32_u24 v95, 336, v85
    v_lshl_add_u32 v95, v86, 5, v95
    v_add_u32 v95, 102400, v95
    v_mul_u32_u24 v55, 2560, v85
    v_lshl_add_u32 v55, v86, 4, v55
    s_waitcnt vmcnt(0) lgkmcnt(0)
    s_barrier
    ds_read_b32 v5, v44 offset:8
    ds_read_b128 v[64:67], v56 offset:0
    ds_read_b128 v[68:71], v56 offset:1024
    ds_read_b128 v[72:75], v56 offset:2048
    ds_read_b128 v[76:79], v57 offset:0
    ds_read_b128 v[80:83], v57 offset:1024
    ds_read_b128 v[84:87], v57 offset:2048
    s_branch L_2
L_1:
    v_add_u32 v4, 0, v1
    v_mul_u32_u24 v5, 6554, v4
    v_lshrrev_b32 v5, 16, v5
    v_mul_u32_u24 v6, 10, v5
    v_sub_u32 v6, v4, v6
    v_lshrrev_b32 v7, 1, v5
    v_and_b32 v7, 4, v7
    v_xor_b32 v5, v5, v7
    v_mul_u32_u24 v5, 1280, v5
    v_lshl_add_u32 v28, v6, 4, v5
    v_add_u32 v4, 64, v1
    v_mul_u32_u24 v5, 6554, v4
    v_lshrrev_b32 v5, 16, v5
    v_mul_u32_u24 v6, 10, v5
    v_sub_u32 v6, v4, v6
    v_lshrrev_b32 v7, 1, v5
    v_and_b32 v7, 4, v7
    v_xor_b32 v5, v5, v7
    v_mul_u32_u24 v5, 1280, v5
    v_lshl_add_u32 v29, v6, 4, v5
    v_add_u32 v4, 128, v1
    v_mul_u32_u24 v5, 6554, v4
    v_lshrrev_b32 v5, 16, v5
    v_mul_u32_u24 v6, 10, v5
    v_sub_u32 v6, v4, v6
    v_lshrrev_b32 v7, 1, v5
    v_and_b32 v7, 4, v7
    v_xor_b32 v5, v5, v7
    v_mul_u32_u24 v5, 1280, v5
    v_lshl_add_u32 v30, v6, 4, v5
    v_add_u32 v4, 192, v1
    v_mul_u32_u24 v5, 6554, v4
    v_lshrrev_b32 v5, 16, v5
    v_mul_u32_u24 v6, 10, v5
    v_sub_u32 v6, v4, v6
    v_lshrrev_b32 v7, 1, v5
    v_and_b32 v7, 4, v7
    v_xor_b32 v5, v5, v7
    v_mul_u32_u24 v5, 1280, v5
    v_lshl_add_u32 v31, v6, 4, v5
    v_add_u32 v4, 256, v1
    v_mul_u32_u24 v5, 6554, v4
    v_lshrrev_b32 v5, 16, v5
    v_mul_u32_u24 v6, 10, v5
    v_sub_u32 v6, v4, v6
    v_lshrrev_b32 v7, 1, v5
    v_and_b32 v7, 4, v7
    v_xor_b32 v5, v5, v7
    v_mul_u32_u24 v5, 1280, v5
    v_lshl_add_u32 v32, v6, 4, v5
    s_sub_u32 s8, s5, 4
    s_mul_i32 s11, s8, 5120
    s_add_u32 s11, s11, 81920
    s_mul_i32 s10, s8, 40960
    s_add_u32 s10, s10, s65
    s_mul_i32 s12, s66, 163840
    s_and_b32 s76, s5, 1
    s_lshr_b32 s77, s5, 1
    v_lshlrev_b32 v62, 4, v1
    v_bfe_u32 v192, v1, 4, 1
    v_mul_u32_u24 v192, 20480, v192
    v_lshl_add_u32 v59, v2, 3, v192
    v_lshl_add_u32 v192, v2, 4, v192
    v_lshrrev_b32 v193, 5, v1
    v_lshl_add_u32 v58, v193, 8, v192
    s_lshl_b32 s8, s3, 2
    s_lshl_b32 s9, s76, 1
    s_add_u32 s8, s8, s9
    s_mul_i32 s8, s8, 20480
    s_add_u32 s8, s8, 262144
    s_lshl_b32 s9, s4, 2
    s_add_u32 s9, s9, s77
    s_lshl_b32 s72, s9, 9
    s_add_u32 s72, s72, s8
    s_lshl_b32 s73, s9, 7
    s_add_u32 s73, s73, s8
    s_add_u32 s73, s73, 16384
    s_lshl_b32 s74, s3, 1
    s_add_u32 s74, s74, s76
    s_lshl_b32 s74, s74, 5
    s_add_u32 s74, s74, s9
    s_lshl_b32 s74, s74, 2
    s_add_u32 s74, s74, 16384
    s_xor_b32 s8, s5, 0
    s_and_b32 s8, s8, 3
    s_mul_i32 s8, s8, 9216
    s_add_u32 s8, s8, 113920
    v_add_u32 v56, s8, v62
    s_xor_b32 s8, s5, 2
    s_and_b32 s8, s8, 3
    s_mul_i32 s8, s8, 9216
    s_add_u32 s8, s8, 113920
    v_add_u32 v57, s8, v62
    v_and_b32 v192, 31, v1
    v_lshlrev_b32 v63, 3, v192
    v_lshrrev_b32 v194, 3, v192
    v_and_b32 v195, 3, v192
    v_lshl_add_u32 v194, v194, 2, v195
    v_bfe_u32 v195, v192, 2, 1
    v_mad_u32_u24 v195, v195, 10, v194
    v_mad_u32_u24 v195, v193, 20, v195
    v_cmp_gt_u32 s[8:9], 10, v194
    v_cmp_lt_u32 vcc, 10, v194
    v_mov_b32 v196, 40
    v_cndmask_b32 v195, v196, v195, s[8:9]
    v_lshlrev_b32 v61, 4, v195
    v_mov_b32 v196, 0x40000000
    v_cndmask_b32 v61, v61, v196, vcc
    s_and_b32 s8, s77, 1
    s_mul_i32 s79, s8, 90112
    s_add_u32 s79, s79, 32768
    s_mul_i32 s8, s76, 5632
    s_add_u32 s8, s8, 102400
    v_mul_u32_u24 v194, 176, v192
    v_add_u32 v194, s8, v194
    v_lshl_add_u32 v195, v193, 4, v194
    v_xor_b32 v196, s77, v193
    v_xor_b32 v197, 2, v196
    v_mad_u32_u24 v180, v196, 40, v194
    v_mad_u32_u24 v181, v197, 40, v194
    s_xor_b32 s8, s77, 0
    s_mul_i32 s8, s8, 40
    v_add_u32 v176, s8, v195
    s_xor_b32 s8, s77, 1
    s_mul_i32 s8, s8, 40
    v_add_u32 v177, s8, v195
    s_xor_b32 s8, s77, 2
    s_mul_i32 s8, s8, 40
    v_add_u32 v178, s8, v195
    s_xor_b32 s8, s77, 3
    s_mul_i32 s8, s8, 40
    v_add_u32 v179, s8, v195
    v_mov_b32 v244, 0
    v_mov_b32 v245, 0
    v_mov_b32 v246, 0
    v_mov_b32 v247, 0
    v_mov_b32 v44, 113664
    s_and_b32 s6, s77, 1
    v_lshrrev_b32 v4, 1, v2
    v_xor_b32 v4, v4, v3
    v_lshlrev_b32 v5, 7, v2
    v_lshl_add_u32 v39, v4, 4, v5
    s_lshl_b32 s7, s76, 1
    s_add_u32 s7, s7, s6
    s_lshl_b32 s8, s7, 11
    s_lshl_b32 s9, s6, 6
    v_xor_b32 v4, s9, v39
    v_add_u32 v34, s8, v4
    v_xor_b32 v35, 0x800, v34
    v_bfe_u32 v4, v1, 2, 2
    v_lshl_add_u32 v4, v3, 3, v4
    v_and_b32 v5, 1, v3
    v_lshl_add_u32 v6, v5, 2, v4
    v_xor_b32 v7, 4, v6
    v_and_b32 v5, 3, v1
    v_lshlrev_b32 v5, 3, v5
    s_movk_i32 s9, 160
    v_mad_u32_u24 v6, v6, s9, v5
    v_mad_u32_u24 v7, v7, s9, v5
    s_mul_i32 s8, s6, 5120
    s_add_u32 s8, s8, 82016
    v_add_u32 v36, s8, v6
    v_add_u32 v37, s8, v7
    s_mul_i32 s8, s76, 51200
    v_add_u32 v52, s8, v6
    v_add_u32 v53, s8, v7
    s_mul_i32 s8, s7, 2816
    s_add_u32 s8, s8, 102496
    v_mul_u32_u24 v4, 176, v2
    v_lshl_add_u32 v4, v3, 3, v4
    v_add_u32 v38, s8, v4
    s_mul_i32 s8, s5, 3072
    s_add_u32 s8, s8, 32768
    v_add_u32 v46, s8, v62
    s_xor_b32 s8, s5, 2
    s_mul_i32 s8, s8, 3072
    s_add_u32 s8, s8, 32768
    v_add_u32 v47, s8, v62
    v_mul_u32_u24 v54, 336, v2
    v_lshl_add_u32 v54, v3, 4, v54
    s_mul_i32 s8, s77, 5376
    s_mul_i32 s9, s76, 21504
    s_add_u32 s8, s8, s9
    s_add_u32 s8, s8, 102400
    v_add_u32 v54, s8, v54
    v_mov_b32 v55, -1
    v_mov_b32 v60, -1
    v_mov_b32 v49, -1
    v_mov_b32 v50, -1
    v_mov_b32 v51, -1
    s_waitcnt lgkmcnt(0)
    s_load_dword s78, s[42:43], 0
    s_mov_b32 s52, s30
    s_mov_b32 s53, s31
    s_mov_b32 s54, 819200
    s_mov_b32 s55, 0x20000
    s_mov_b32 s44, s42
    s_mov_b32 s45, s43
    s_mov_b32 s46, 10747904
    s_mov_b32 s47, 0x20000
    s_waitcnt lgkmcnt(0)
    s_mul_i32 s78, s78, 0x9E3779B1
    s_add_u32 s78, s78, 0x7F4A7C15
    s_setprio 0
    s_barrier
    s_add_u32 s8, s10, s12
    s_add_u32 m0, s11, 0
    s_nop 0
    buffer_load_dwordx4 v28, s[52:55], s8 offen lds
    s_add_u32 m0, s11, 1024
    s_nop 0
    buffer_load_dwordx4 v29, s[52:55], s8 offen lds
    s_add_u32 m0, s11, 2048
    s_nop 0
    buffer_load_dwordx4 v30, s[52:55], s8 offen lds
    s_add_u32 m0, s11, 3072
    s_nop 0
    buffer_load_dwordx4 v31, s[52:55], s8 offen lds
    s_add_u32 m0, s11, 4096
    s_nop 0
    buffer_load_dwordx4 v32, s[52:55], s8 offen lds
    s_add_u32 s12, s12, 163840
    s_cmp_ge_u32 s12, 819200
    s_cselect_b32 s12, 0, s12
    s_waitcnt vmcnt(5)
    s_add_u32 s8, s10, s12
    s_add_u32 m0, s11, 20480
    s_nop 0
    buffer_load_dwordx4 v28, s[52:55], s8 offen lds
    s_add_u32 m0, s11, 21504
    s_nop 0
    buffer_load_dwordx4 v29, s[52:55], s8 offen lds
    s_add_u32 m0, s11, 22528
    s_nop 0
    buffer_load_dwordx4 v30, s[52:55], s8 offen lds
    s_add_u32 m0, s11, 23552
    s_nop 0
    buffer_load_dwordx4 v31, s[52:55], s8 offen lds
    s_add_u32 m0, s11, 24576
    s_nop 0
    buffer_load_dwordx4 v32, s[52:55], s8 offen lds
    s_add_u32 s12, s12, 163840
    s_cmp_ge_u32 s12, 819200
    s_cselect_b32 s12, 0, s12
    s_waitcnt vmcnt(5)
    s_cmp_eq_u32 s5, 7
    s_cbranch_scc1 L_51
    s_add_u32 s8, s10, s12
    s_add_u32 m0, s11, 40960
    s_nop 0
    buffer_load_dwordx4 v28, s[52:55], s8 offen lds
    s_add_u32 m0, s11, 41984
    s_nop 0
    buffer_load_dwordx4 v29, s[52:55], s8 offen lds
    s_add_u32 m0, s11, 43008
    s_nop 0
    buffer_load_dwordx4 v30, s[52:55], s8 offen lds
    s_add_u32 m0, s11, 44032
    s_nop 0
    buffer_load_dwordx4 v31, s[52:55], s8 offen lds
    s_add_u32 m0, s11, 45056
    s_nop 0
    buffer_load_dwordx4 v32, s[52:55], s8 offen lds
    s_add_u32 s12, s12, 163840
    s_cmp_ge_u32 s12, 819200
    s_cselect_b32 s12, 0, s12
L_51:
    s_barrier
    ds_read_b128 v[96:99], v34 offset:0
    ds_read_b128 v[100:103], v35 offset:0
    ds_read_b64_tr_b16 v[104:105], v36 offset:0
    ds_read_b64_tr_b16 v[106:107], v37 offset:0
    ds_read_b64_tr_b16 v[108:109], v36 offset:32
    ds_read_b64_tr_b16 v[110:111], v37 offset:32
    ds_read_b128 v[116:119], v34 offset:8192
    ds_read_b128 v[120:123], v35 offset:8192
    ds_read_b64_tr_b16 v[124:125], v36 offset:10240
    ds_read_b64_tr_b16 v[126:127], v37 offset:10240
    ds_read_b64_tr_b16 v[128:129], v36 offset:10272
    ds_read_b64_tr_b16 v[130:131], v37 offset:10272
    s_cmp_lg_u32 s5, 7
    s_cbranch_scc1 L_52
    s_add_u32 s8, s10, s12
    s_add_u32 m0, s11, 40960
    s_nop 0
    buffer_load_dwordx4 v28, s[52:55], s8 offen lds
    s_add_u32 m0, s11, 41984
    s_nop 0
    buffer_load_dwordx4 v29, s[52:55], s8 offen lds
    s_add_u32 m0, s11, 43008
    s_nop 0
    buffer_load_dwordx4 v30, s[52:55], s8 offen lds
    s_add_u32 m0, s11, 44032
    s_nop 0
    buffer_load_dwordx4 v31, s[52:55], s8 offen lds
    s_add_u32 m0, s11, 45056
    s_nop 0
    buffer_load_dwordx4 v32, s[52:55], s8 offen lds
    s_add_u32 s12, s12, 163840
    s_cmp_ge_u32 s12, 819200
    s_cselect_b32 s12, 0, s12
L_52:
    s_add_u32 s8, s10, s12
    s_add_u32 m0, s11, 61440
    s_nop 0
    buffer_load_dwordx4 v28, s[52:55], s8 offen lds
    s_add_u32 m0, s11, 62464
    s_nop 0
    buffer_load_dwordx4 v29, s[52:55], s8 offen lds
    s_add_u32 m0, s11, 63488
    s_nop 0
    buffer_load_dwordx4 v30, s[52:55], s8 offen lds
    s_add_u32 m0, s11, 64512
    s_nop 0
    buffer_load_dwordx4 v31, s[52:55], s8 offen lds
    s_add_u32 m0, s11, 65536
    s_nop 0
    buffer_load_dwordx4 v32, s[52:55], s8 offen lds
    s_add_u32 s12, s12, 163840
    s_cmp_ge_u32 s12, 819200
    s_cselect_b32 s12, 0, s12
    s_waitcnt lgkmcnt(6)
    v_mfma_f32_16x16x32_bf16 v[64:67], v[104:107], v[96:99], 0
    v_mfma_f32_16x16x32_bf16 v[76:79], v[104:107], v[100:103], 0
    v_mfma_f32_16x16x32_bf16 v[68:71], v[108:111], v[96:99], 0
    v_mfma_f32_16x16x32_bf16 v[80:83], v[108:111], v[100:103], 0
    s_waitcnt lgkmcnt(0)
    v_mfma_f32_16x16x32_bf16 v[64:67], v[124:127], v[116:119], v[64:67]
    v_mfma_f32_16x16x32_bf16 v[76:79], v[124:127], v[120:123], v[76:79]
    v_mfma_f32_16x16x32_bf16 v[68:71], v[128:131], v[116:119], v[68:71]
    v_mfma_f32_16x16x32_bf16 v[80:83], v[128:131], v[120:123], v[80:83]
    s_waitcnt vmcnt(10)
    s_barrier
    ds_read_b128 v[96:99], v34 offset:16384
    ds_read_b128 v[100:103], v35 offset:16384
    ds_read_b64_tr_b16 v[104:105], v36 offset:20480
    ds_read_b64_tr_b16 v[106:107], v37 offset:20480
    ds_read_b64_tr_b16 v[108:109], v36 offset:20512
    ds_read_b64_tr_b16 v[110:111], v37 offset:20512
    ds_read_b128 v[116:119], v34 offset:24576
    ds_read_b128 v[120:123], v35 offset:24576
    ds_read_b64_tr_b16 v[124:125], v36 offset:30720
    ds_read_b64_tr_b16 v[126:127], v37 offset:30720
    ds_read_b64_tr_b16 v[128:129], v36 offset:30752
    ds_read_b64_tr_b16 v[130:131], v37 offset:30752
    s_add_u32 s8, s10, s12
    s_add_u32 m0, s11, 0
    s_nop 0
    buffer_load_dwordx4 v28, s[52:55], s8 offen lds
    s_add_u32 m0, s11, 1024
    s_nop 0
    buffer_load_dwordx4 v29, s[52:55], s8 offen lds
    s_add_u32 m0, s11, 2048
    s_nop 0
    buffer_load_dwordx4 v30, s[52:55], s8 offen lds
    s_add_u32 m0, s11, 3072
    s_nop 0
    buffer_load_dwordx4 v31, s[52:55], s8 offen lds
    s_add_u32 m0, s11, 4096
    s_nop 0
    buffer_load_dwordx4 v32, s[52:55], s8 offen lds
    s_waitcnt lgkmcnt(6)
    v_mfma_f32_16x16x32_bf16 v[64:67], v[104:107], v[96:99], v[64:67]
    v_mfma_f32_16x16x32_bf16 v[76:79], v[104:107], v[100:103], v[76:79]
    v_mfma_f32_16x16x32_bf16 v[68:71], v[108:111], v[96:99], v[68:71]
    v_mfma_f32_16x16x32_bf16 v[80:83], v[108:111], v[100:103], v[80:83]
    s_waitcnt lgkmcnt(0)
    v_mfma_f32_16x16x32_bf16 v[64:67], v[124:127], v[116:119], v[64:67]
    v_mfma_f32_16x16x32_bf16 v[76:79], v[124:127], v[120:123], v[76:79]
    v_mfma_f32_16x16x32_bf16 v[68:71], v[128:131], v[116:119], v[68:71]
    v_mfma_f32_16x16x32_bf16 v[80:83], v[128:131], v[120:123], v[80:83]
    v_add_u32 v36, 40960, v36
    v_add_u32 v37, 40960, v37
    s_waitcnt vmcnt(5)
    s_barrier
    ds_read_b128 v[96:99], v34 offset:32768
    ds_read_b128 v[100:103], v35 offset:32768
    ds_read_b64_tr_b16 v[104:105], v36 offset:0
    ds_read_b64_tr_b16 v[106:107], v37 offset:0
    ds_read_b64_tr_b16 v[108:109], v36 offset:32
    ds_read_b64_tr_b16 v[110:111], v37 offset:32
    ds_read_b128 v[116:119], v34 offset:40960
    ds_read_b128 v[120:123], v35 offset:40960
    ds_read_b64_tr_b16 v[124:125], v36 offset:10240
    ds_read_b64_tr_b16 v[126:127], v37 offset:10240
    ds_read_b64_tr_b16 v[128:129], v36 offset:10272
    ds_read_b64_tr_b16 v[130:131], v37 offset:10272
    ds_read_b128 v[136:139], v34 offset:49152
    ds_read_b128 v[140:143], v35 offset:49152
    ds_read_b64_tr_b16 v[144:145], v36 offset:20480
    ds_read_b64_tr_b16 v[146:147], v37 offset:20480
    ds_read_b64_tr_b16 v[148:149], v36 offset:20512
    ds_read_b64_tr_b16 v[150:151], v37 offset:20512
    ds_read_b128 v[156:159], v34 offset:57344
    ds_read_b128 v[160:163], v35 offset:57344
    ds_read_b64_tr_b16 v[164:165], v36 offset:30720
    ds_read_b64_tr_b16 v[166:167], v37 offset:30720
    ds_read_b64_tr_b16 v[168:169], v36 offset:30752
    ds_read_b64_tr_b16 v[170:171], v37 offset:30752
    s_waitcnt lgkmcnt(15)
    v_mfma_f32_16x16x32_bf16 v[64:67], v[104:107], v[96:99], v[64:67]
    v_mfma_f32_16x16x32_bf16 v[76:79], v[104:107], v[100:103], v[76:79]
    v_mfma_f32_16x16x32_bf16 v[68:71], v[108:111], v[96:99], v[68:71]
    v_mfma_f32_16x16x32_bf16 v[80:83], v[108:111], v[100:103], v[80:83]
    s_waitcnt lgkmcnt(12)
    v_mfma_f32_16x16x32_bf16 v[64:67], v[124:127], v[116:119], v[64:67]
    v_mfma_f32_16x16x32_bf16 v[76:79], v[124:127], v[120:123], v[76:79]
    v_mfma_f32_16x16x32_bf16 v[68:71], v[128:131], v[116:119], v[68:71]
    v_mfma_f32_16x16x32_bf16 v[80:83], v[128:131], v[120:123], v[80:83]
    s_waitcnt lgkmcnt(6)
    v_mfma_f32_16x16x32_bf16 v[64:67], v[144:147], v[136:139], v[64:67]
    v_mfma_f32_16x16x32_bf16 v[76:79], v[144:147], v[140:143], v[76:79]
    v_mfma_f32_16x16x32_bf16 v[68:71], v[148:151], v[136:139], v[68:71]
    v_mfma_f32_16x16x32_bf16 v[80:83], v[148:151], v[140:143], v[80:83]
    s_waitcnt lgkmcnt(0)
    v_mfma_f32_16x16x32_bf16 v[64:67], v[164:167], v[156:159], v[64:67]
    v_mfma_f32_16x16x32_bf16 v[76:79], v[164:167], v[160:163], v[76:79]
    v_mfma_f32_16x16x32_bf16 v[68:71], v[168:171], v[156:159], v[68:71]
    v_mfma_f32_16x16x32_bf16 v[80:83], v[168:171], v[160:163], v[80:83]
    v_add_u32 v36, 4294926336, v36
    v_add_u32 v37, 4294926336, v37
    v_add_u32 v34, 65536, v34
    v_add_u32 v35, 65536, v35
    s_waitcnt vmcnt(0)
    s_barrier
    ds_read_b128 v[96:99], v34 offset:0
    ds_read_b128 v[100:103], v35 offset:0
    ds_read_b64_tr_b16 v[104:105], v36 offset:0
    ds_read_b64_tr_b16 v[106:107], v37 offset:0
    ds_read_b64_tr_b16 v[108:109], v36 offset:32
    ds_read_b64_tr_b16 v[110:111], v37 offset:32
    ds_read_b128 v[116:119], v34 offset:8192
    ds_read_b128 v[120:123], v35 offset:8192
    ds_read_b64_tr_b16 v[124:125], v36 offset:10240
    ds_read_b64_tr_b16 v[126:127], v37 offset:10240
    ds_read_b64_tr_b16 v[128:129], v36 offset:10272
    ds_read_b64_tr_b16 v[130:131], v37 offset:10272
    s_mov_b32 s11, s79
    buffer_load_dwordx4 v[192:195], v62, s[44:47], s11 offen offset:256 sc1
    buffer_load_dwordx2 v[196:197], v63, s[44:47], s11 offen offset:0 sc1
    buffer_load_dwordx4 v[198:201], v61, s[44:47], s11 offen offset:1280 sc1
    buffer_load_dwordx4 v[202:205], v61, s[44:47], s11 offen offset:2048 sc1
    buffer_load_dwordx4 v[206:209], v62, s[44:47], s11 offen offset:3072 sc1
    buffer_load_dwordx2 v[210:211], v63, s[44:47], s11 offen offset:2816 sc1
    s_add_u32 s11, s11, 2816
    s_waitcnt lgkmcnt(6)
    v_mfma_f32_16x16x32_bf16 v[64:67], v[104:107], v[96:99], v[64:67]
    v_mfma_f32_16x16x32_bf16 v[76:79], v[104:107], v[100:103], v[76:79]
    v_mfma_f32_16x16x32_bf16 v[68:71], v[108:111], v[96:99], v[68:71]
    v_mfma_f32_16x16x32_bf16 v[80:83], v[108:111], v[100:103], v[80:83]
    s_waitcnt lgkmcnt(0)
    v_mfma_f32_16x16x32_bf16 v[64:67], v[124:127], v[116:119], v[64:67]
    v_mfma_f32_16x16x32_bf16 v[76:79], v[124:127], v[120:123], v[76:79]
    v_mfma_f32_16x16x32_bf16 v[68:71], v[128:131], v[116:119], v[68:71]
    v_mfma_f32_16x16x32_bf16 v[80:83], v[128:131], v[120:123], v[80:83]
    s_nop 5
    ds_write_b128 v46, v[76:79] offset:0
    s_nop 0
    ds_write_b128 v46, v[80:83] offset:1024
    s_mov_b32 s8, 0xffff0000
    s_mov_b32 s9, 1051011932
    s_waitcnt lgkmcnt(0)
    s_barrier
    ds_read_b128 v[76:79], v47 offset:0
    ds_read_b128 v[80:83], v47 offset:1024
    s_waitcnt lgkmcnt(1)
    v_add_f32 v64, v64, v76
    v_add_f32 v65, v65, v77
    v_add_f32 v66, v66, v78
    v_add_f32 v67, v67, v79
    v_mul_f32 v64, s9, v64
    v_mul_f32 v65, s9, v65
    v_mul_f32 v66, s9, v66
    v_mul_f32 v67, s9, v67
    v_cvt_pk_bf16_f32 v88, v64, v65
    v_cvt_pk_bf16_f32 v89, v66, v67
    ds_write_b64 v38, v[88:89] offset:0
    s_waitcnt lgkmcnt(1)
    v_add_f32 v68, v68, v80
    v_add_f32 v69, v69, v81
    v_add_f32 v70, v70, v82
    v_add_f32 v71, v71, v83
    v_mul_f32 v68, s9, v68
    v_mul_f32 v69, s9, v69
    v_mul_f32 v70, s9, v70
    v_mul_f32 v71, s9, v71
    v_cvt_pk_bf16_f32 v90, v68, v69
    v_cvt_pk_bf16_f32 v91, v70, v71
    ds_write_b64 v38, v[90:91] offset:32
    s_waitcnt lgkmcnt(0)
    s_barrier
    ds_read2_b64 v[8:11], v176 offset0:0 offset1:1
    ds_read2_b64 v[12:15], v177 offset0:0 offset1:1
    ds_read2_b64 v[16:19], v178 offset0:0 offset1:1
    ds_read2_b64 v[20:23], v179 offset0:0 offset1:1
    ds_read_b64 v[24:25], v180 offset:32
    ds_read_b64 v[26:27], v181 offset:32
    s_setprio 1
    s_movk_i32 s13, 8
    v_mfma_f32_32x32x16_bf16 v[64:79], v[244:247], v[244:247], 0
    v_mfma_f32_32x32x16_bf16 v[80:95], v[244:247], v[244:247], 0
    v_mfma_f32_32x32x16_bf16 v[96:111], v[244:247], v[244:247], 0
    v_mfma_f32_32x32x16_bf16 v[112:127], v[244:247], v[244:247], 0
    s_waitcnt vmcnt(4) lgkmcnt(0)
    v_mfma_f32_32x32x16_bf16 v[128:143], v[192:195], v[8:11], 0
    v_mfma_f32_32x32x16_bf16 v[144:159], v[192:195], v[12:15], 0
    v_mov_b32 v184, 0
    v_mov_b32 v185, 0
    v_mov_b32 v186, 0
    v_mov_b32 v187, 0
    v_mov_b32 v188, 0
    v_mov_b32 v189, 0
    v_mov_b32 v190, 0
    v_mov_b32 v191, 0
    v_mov_b32 v176, 0
    v_mov_b32 v240, 0
    v_mov_b32 v177, 0
    v_mov_b32 v241, 0
    v_mov_b32 v178, 0
    v_mov_b32 v242, 0
    v_mov_b32 v179, 0
    v_mov_b32 v243, 0
    v_mfma_f32_32x32x4_2b_bf16 v[128:159], v[196:197], v[24:25], v[128:159]
    buffer_load_dwordx4 v[212:215], v61, s[44:47], s11 offen offset:1280 sc1
    buffer_load_dwordx4 v[216:219], v61, s[44:47], s11 offen offset:2048 sc1
    buffer_load_dwordx4 v[220:223], v62, s[44:47], s11 offen offset:3072 sc1
    buffer_load_dwordx2 v[224:225], v63, s[44:47], s11 offen offset:2816 sc1
    s_add_u32 s11, s11, 2816
    buffer_load_dwordx4 v[226:229], v61, s[44:47], s11 offen offset:1280 sc1
    buffer_load_dwordx4 v[230:233], v61, s[44:47], s11 offen offset:2048 sc1
    buffer_load_dwordx4 v[234:237], v62, s[44:47], s11 offen offset:3072 sc1
    buffer_load_dwordx2 v[238:239], v63, s[44:47], s11 offen offset:2816 sc1
    s_add_u32 s11, s11, 2816
    s_nop 9
    .p2align 6
L_55:
    v_exp_f32 v128, v128
    v_exp_f32 v129, v129
    v_exp_f32 v130, v130
    v_exp_f32 v131, v131
    v_mfma_f32_32x32x16_bf16 v[112:127], v[240:243], v[176:179], v[112:127]
    v_cvt_pk_bf16_f32 v186, v188, v189
    v_cvt_pk_bf16_f32 v187, v190, v191
    v_exp_f32 v132, v132
    v_exp_f32 v133, v133
    v_mfma_f32_32x32x16_bf16 v[112:127], v[244:247], v[184:187], v[112:127]
    v_exp_f32 v134, v134
    v_exp_f32 v135, v135
    v_cvt_pk_bf16_f32 v128, v128, v129
    v_cvt_pk_bf16_f32 v129, v130, v131
    v_mfma_f32_32x32x16_bf16 v[176:191], v[192:195], v[20:23], 0
    v_exp_f32 v136, v136
    v_exp_f32 v137, v137
    v_exp_f32 v138, v138
    v_exp_f32 v139, v139
    v_mfma_f32_32x32x16_bf16 v[160:175], v[192:195], v[16:19], 0
    v_cvt_pk_bf16_f32 v130, v132, v133
    v_cvt_pk_bf16_f32 v131, v134, v135
    v_exp_f32 v140, v140
    v_exp_f32_e64 v141, v141
    s_waitcnt vmcnt(8)
    v_mfma_f32_32x32x16_bf16 v[64:79], v[198:201], v[128:131], v[64:79]
    v_exp_f32 v142, v142
    v_exp_f32 v143, v143
    v_cvt_pk_bf16_f32 v136, v136, v137
    v_cvt_pk_bf16_f32 v137, v138, v139
    v_exp_f32 v144, v144
    v_exp_f32 v145, v145
    v_mfma_f32_32x32x4_2b_bf16 v[160:191], v[196:197], v[26:27], v[160:191]
    v_exp_f32 v146, v146
    v_exp_f32 v147, v147
    v_cvt_pk_bf16_f32 v138, v140, v141
    v_cvt_pk_bf16_f32 v139, v142, v143
    v_exp_f32 v148, v148
    v_exp_f32 v149, v149
    v_exp_f32 v150, v150
    v_exp_f32 v151, v151
    v_cvt_pk_bf16_f32 v144, v144, v145
    v_cvt_pk_bf16_f32 v145, v146, v147
    v_mfma_f32_32x32x16_bf16 v[64:79], v[202:205], v[136:139], v[64:79]
    buffer_load_dwordx4 v[240:243], v61, s[44:47], s11 offen offset:1280
    buffer_load_dwordx4 v[244:247], v61, s[44:47], s11 offen offset:2048
    buffer_load_dwordx4 v[192:195], v62, s[44:47], s11 offen offset:3072
    buffer_load_dwordx2 v[196:197], v63, s[44:47], s11 offen offset:2816
    s_add_u32 s11, s11, 2816
    v_exp_f32 v152, v152
    v_exp_f32 v153, v153
    v_exp_f32 v154, v154
    v_exp_f32 v155, v155
    v_cvt_pk_bf16_f32 v146, v148, v149
    v_cvt_pk_bf16_f32 v147, v150, v151
    v_exp_f32 v156, v156
    v_exp_f32 v157, v157
    v_exp_f32 v158, v158
    v_exp_f32 v159, v159
    v_cvt_pk_bf16_f32 v152, v152, v153
    v_cvt_pk_bf16_f32 v153, v154, v155
    v_exp_f32 v160, v160
    v_exp_f32 v161, v161
    v_exp_f32 v162, v162
    v_exp_f32 v163, v163
    v_mfma_f32_32x32x16_bf16 v[80:95], v[198:201], v[144:147], v[80:95]
    v_cvt_pk_bf16_f32 v154, v156, v157
    v_cvt_pk_bf16_f32 v155, v158, v159
    v_exp_f32 v164, v164
    v_exp_f32 v165, v165
    v_mfma_f32_32x32x16_bf16 v[80:95], v[202:205], v[152:155], v[80:95]
    v_exp_f32 v166, v166
    v_exp_f32 v167, v167
    v_cvt_pk_bf16_f32 v160, v160, v161
    v_cvt_pk_bf16_f32 v161, v162, v163
    v_mfma_f32_32x32x16_bf16 v[144:159], v[206:209], v[12:15], 0
    v_exp_f32 v168, v168
    v_exp_f32 v169, v169
    v_exp_f32 v170, v170
    v_exp_f32 v171, v171
    v_mfma_f32_32x32x16_bf16 v[128:143], v[206:209], v[8:11], 0
    v_cvt_pk_bf16_f32 v162, v164, v165
    v_cvt_pk_bf16_f32 v163, v166, v167
    v_exp_f32 v172, v172
    v_exp_f32 v173, v173
    v_mfma_f32_32x32x16_bf16 v[96:111], v[198:201], v[160:163], v[96:111]
    v_exp_f32 v174, v174
    v_exp_f32 v175, v175
    v_cvt_pk_bf16_f32 v168, v168, v169
    v_cvt_pk_bf16_f32 v169, v170, v171
    v_exp_f32 v176, v176
    v_exp_f32 v177, v177
    v_mfma_f32_32x32x4_2b_bf16 v[128:159], v[210:211], v[24:25], v[128:159]
    v_exp_f32 v178, v178
    v_exp_f32 v179, v179
    v_cvt_pk_bf16_f32 v170, v172, v173
    v_cvt_pk_bf16_f32 v171, v174, v175
    v_exp_f32 v180, v180
    v_exp_f32 v181, v181
    v_exp_f32 v182, v182
    v_exp_f32 v183, v183
    v_cvt_pk_bf16_f32 v176, v176, v177
    v_cvt_pk_bf16_f32 v177, v178, v179
    v_mfma_f32_32x32x16_bf16 v[96:111], v[202:205], v[168:171], v[96:111]
    v_exp_f32 v184, v184
    v_exp_f32 v185, v185
    v_exp_f32 v186, v186
    v_exp_f32 v187, v187
    v_cvt_pk_bf16_f32 v178, v180, v181
    v_cvt_pk_bf16_f32 v179, v182, v183
    v_exp_f32 v188, v188
    v_exp_f32 v189, v189
    v_exp_f32 v190, v190
    v_exp_f32 v191, v191
    v_cvt_pk_bf16_f32 v184, v184, v185
    v_cvt_pk_bf16_f32 v185, v186, v187
    v_exp_f32 v128, v128
    v_exp_f32 v129, v129
    v_exp_f32 v130, v130
    v_exp_f32 v131, v131
    v_mfma_f32_32x32x16_bf16 v[112:127], v[198:201], v[176:179], v[112:127]
    v_cvt_pk_bf16_f32 v186, v188, v189
    v_cvt_pk_bf16_f32 v187, v190, v191
    v_exp_f32 v132, v132
    v_exp_f32 v133, v133
    v_mfma_f32_32x32x16_bf16 v[112:127], v[202:205], v[184:187], v[112:127]
    v_exp_f32 v134, v134
    v_exp_f32 v135, v135
    v_cvt_pk_bf16_f32 v128, v128, v129
    v_cvt_pk_bf16_f32 v129, v130, v131
    v_mfma_f32_32x32x16_bf16 v[176:191], v[206:209], v[20:23], 0
    v_exp_f32 v136, v136
    v_exp_f32 v137, v137
    v_exp_f32 v138, v138
    v_exp_f32 v139, v139
    v_mfma_f32_32x32x16_bf16 v[160:175], v[206:209], v[16:19], 0
    v_cvt_pk_bf16_f32 v130, v132, v133
    v_cvt_pk_bf16_f32 v131, v134, v135
    v_exp_f32 v140, v140
    v_exp_f32_e64 v141, v141
    s_waitcnt vmcnt(8)
    v_mfma_f32_32x32x16_bf16 v[64:79], v[212:215], v[128:131], v[64:79]
    v_exp_f32 v142, v142
    v_exp_f32 v143, v143
    v_cvt_pk_bf16_f32 v136, v136, v137
    v_cvt_pk_bf16_f32 v137, v138, v139
    v_exp_f32 v144, v144
    v_exp_f32 v145, v145
    v_mfma_f32_32x32x4_2b_bf16 v[160:191], v[210:211], v[26:27], v[160:191]
    v_exp_f32 v146, v146
    v_exp_f32 v147, v147
    v_cvt_pk_bf16_f32 v138, v140, v141
    v_cvt_pk_bf16_f32 v139, v142, v143
    v_exp_f32 v148, v148
    v_exp_f32 v149, v149
    v_exp_f32 v150, v150
    v_exp_f32 v151, v151
    v_cvt_pk_bf16_f32 v144, v144, v145
    v_cvt_pk_bf16_f32 v145, v146, v147
    v_mfma_f32_32x32x16_bf16 v[64:79], v[216:219], v[136:139], v[64:79]
    buffer_load_dwordx4 v[198:201], v61, s[44:47], s11 offen offset:1280
    buffer_load_dwordx4 v[202:205], v61, s[44:47], s11 offen offset:2048
    buffer_load_dwordx4 v[206:209], v62, s[44:47], s11 offen offset:3072
    buffer_load_dwordx2 v[210:211], v63, s[44:47], s11 offen offset:2816
    s_add_u32 s11, s11, 2816
    v_exp_f32 v152, v152
    v_exp_f32 v153, v153
    v_exp_f32 v154, v154
    v_exp_f32 v155, v155
    v_cvt_pk_bf16_f32 v146, v148, v149
    v_cvt_pk_bf16_f32 v147, v150, v151
    v_exp_f32 v156, v156
    v_exp_f32 v157, v157
    v_exp_f32 v158, v158
    v_exp_f32 v159, v159
    v_cvt_pk_bf16_f32 v152, v152, v153
    v_cvt_pk_bf16_f32 v153, v154, v155
    v_exp_f32 v160, v160
    v_exp_f32 v161, v161
    v_exp_f32 v162, v162
    v_exp_f32 v163, v163
    v_mfma_f32_32x32x16_bf16 v[80:95], v[212:215], v[144:147], v[80:95]
    v_cvt_pk_bf16_f32 v154, v156, v157
    v_cvt_pk_bf16_f32 v155, v158, v159
    v_exp_f32 v164, v164
    v_exp_f32 v165, v165
    v_mfma_f32_32x32x16_bf16 v[80:95], v[216:219], v[152:155], v[80:95]
    v_exp_f32 v166, v166
    v_exp_f32 v167, v167
    v_cvt_pk_bf16_f32 v160, v160, v161
    v_cvt_pk_bf16_f32 v161, v162, v163
    v_mfma_f32_32x32x16_bf16 v[144:159], v[220:223], v[12:15], 0
    v_exp_f32 v168, v168
    v_exp_f32 v169, v169
    v_exp_f32 v170, v170
    v_exp_f32 v171, v171
    v_mfma_f32_32x32x16_bf16 v[128:143], v[220:223], v[8:11], 0
    v_cvt_pk_bf16_f32 v162, v164, v165
    v_cvt_pk_bf16_f32 v163, v166, v167
    v_exp_f32 v172, v172
    v_exp_f32 v173, v173
    v_mfma_f32_32x32x16_bf16 v[96:111], v[212:215], v[160:163], v[96:111]
    v_exp_f32 v174, v174
    v_exp_f32 v175, v175
    v_cvt_pk_bf16_f32 v168, v168, v169
    v_cvt_pk_bf16_f32 v169, v170, v171
    v_exp_f32 v176, v176
    v_exp_f32 v177, v177
    v_mfma_f32_32x32x4_2b_bf16 v[128:159], v[224:225], v[24:25], v[128:159]
    v_exp_f32 v178, v178
    v_exp_f32 v179, v179
    v_cvt_pk_bf16_f32 v170, v172, v173
    v_cvt_pk_bf16_f32 v171, v174, v175
    v_exp_f32 v180, v180
    v_exp_f32 v181, v181
    v_exp_f32 v182, v182
    v_exp_f32 v183, v183
    v_cvt_pk_bf16_f32 v176, v176, v177
    v_cvt_pk_bf16_f32 v177, v178, v179
    v_mfma_f32_32x32x16_bf16 v[96:111], v[216:219], v[168:171], v[96:111]
    v_exp_f32 v184, v184
    v_exp_f32 v185, v185
    v_exp_f32 v186, v186
    v_exp_f32 v187, v187
    v_cvt_pk_bf16_f32 v178, v180, v181
    v_cvt_pk_bf16_f32 v179, v182, v183
    v_exp_f32 v188, v188
    v_exp_f32 v189, v189
    v_exp_f32 v190, v190
    v_exp_f32 v191, v191
    v_cvt_pk_bf16_f32 v184, v184, v185
    v_cvt_pk_bf16_f32 v185, v186, v187
    v_exp_f32 v128, v128
    v_exp_f32 v129, v129
    v_exp_f32 v130, v130
    v_exp_f32 v131, v131
    v_mfma_f32_32x32x16_bf16 v[112:127], v[212:215], v[176:179], v[112:127]
    v_cvt_pk_bf16_f32 v186, v188, v189
    v_cvt_pk_bf16_f32 v187, v190, v191
    v_exp_f32 v132, v132
    v_exp_f32 v133, v133
    v_mfma_f32_32x32x16_bf16 v[112:127], v[216:219], v[184:187], v[112:127]
    v_exp_f32 v134, v134
    v_exp_f32 v135, v135
    v_cvt_pk_bf16_f32 v128, v128, v129
    v_cvt_pk_bf16_f32 v129, v130, v131
    v_mfma_f32_32x32x16_bf16 v[176:191], v[220:223], v[20:23], 0
    v_exp_f32 v136, v136
    v_exp_f32 v137, v137
    v_exp_f32 v138, v138
    v_exp_f32 v139, v139
    v_mfma_f32_32x32x16_bf16 v[160:175], v[220:223], v[16:19], 0
    v_cvt_pk_bf16_f32 v130, v132, v133
    v_cvt_pk_bf16_f32 v131, v134, v135
    v_exp_f32 v140, v140
    v_exp_f32_e64 v141, v141
    s_waitcnt vmcnt(8)
    v_mfma_f32_32x32x16_bf16 v[64:79], v[226:229], v[128:131], v[64:79]
    v_exp_f32 v142, v142
    v_exp_f32 v143, v143
    v_cvt_pk_bf16_f32 v136, v136, v137
    v_cvt_pk_bf16_f32 v137, v138, v139
    v_exp_f32 v144, v144
    v_exp_f32 v145, v145
    v_mfma_f32_32x32x4_2b_bf16 v[160:191], v[224:225], v[26:27], v[160:191]
    v_exp_f32 v146, v146
    v_exp_f32 v147, v147
    v_cvt_pk_bf16_f32 v138, v140, v141
    v_cvt_pk_bf16_f32 v139, v142, v143
    v_exp_f32 v148, v148
    v_exp_f32 v149, v149
    v_exp_f32 v150, v150
    v_exp_f32 v151, v151
    v_cvt_pk_bf16_f32 v144, v144, v145
    v_cvt_pk_bf16_f32 v145, v146, v147
    v_mfma_f32_32x32x16_bf16 v[64:79], v[230:233], v[136:139], v[64:79]
    buffer_load_dwordx4 v[212:215], v61, s[44:47], s11 offen offset:1280
    buffer_load_dwordx4 v[216:219], v61, s[44:47], s11 offen offset:2048
    buffer_load_dwordx4 v[220:223], v62, s[44:47], s11 offen offset:3072
    buffer_load_dwordx2 v[224:225], v63, s[44:47], s11 offen offset:2816
    s_add_u32 s11, s11, 2816
    v_exp_f32 v152, v152
    v_exp_f32 v153, v153
    v_exp_f32 v154, v154
    v_exp_f32 v155, v155
    v_cvt_pk_bf16_f32 v146, v148, v149
    v_cvt_pk_bf16_f32 v147, v150, v151
    v_exp_f32 v156, v156
    v_exp_f32 v157, v157
    v_exp_f32 v158, v158
    v_exp_f32 v159, v159
    v_cvt_pk_bf16_f32 v152, v152, v153
    v_cvt_pk_bf16_f32 v153, v154, v155
    v_exp_f32 v160, v160
    v_exp_f32 v161, v161
    v_exp_f32 v162, v162
    v_exp_f32 v163, v163
    v_mfma_f32_32x32x16_bf16 v[80:95], v[226:229], v[144:147], v[80:95]
    v_cvt_pk_bf16_f32 v154, v156, v157
    v_cvt_pk_bf16_f32 v155, v158, v159
    v_exp_f32 v164, v164
    v_exp_f32 v165, v165
    v_mfma_f32_32x32x16_bf16 v[80:95], v[230:233], v[152:155], v[80:95]
    v_exp_f32 v166, v166
    v_exp_f32 v167, v167
    v_cvt_pk_bf16_f32 v160, v160, v161
    v_cvt_pk_bf16_f32 v161, v162, v163
    v_mfma_f32_32x32x16_bf16 v[144:159], v[234:237], v[12:15], 0
    v_exp_f32 v168, v168
    v_exp_f32 v169, v169
    v_exp_f32 v170, v170
    v_exp_f32 v171, v171
    v_mfma_f32_32x32x16_bf16 v[128:143], v[234:237], v[8:11], 0
    v_cvt_pk_bf16_f32 v162, v164, v165
    v_cvt_pk_bf16_f32 v163, v166, v167
    v_exp_f32 v172, v172
    v_exp_f32 v173, v173
    v_mfma_f32_32x32x16_bf16 v[96:111], v[226:229], v[160:163], v[96:111]
    v_exp_f32 v174, v174
    v_exp_f32 v175, v175
    v_cvt_pk_bf16_f32 v168, v168, v169
    v_cvt_pk_bf16_f32 v169, v170, v171
    v_exp_f32 v176, v176
    v_exp_f32 v177, v177
    v_mfma_f32_32x32x4_2b_bf16 v[128:159], v[238:239], v[24:25], v[128:159]
    v_exp_f32 v178, v178
    v_exp_f32 v179, v179
    v_cvt_pk_bf16_f32 v170, v172, v173
    v_cvt_pk_bf16_f32 v171, v174, v175
    v_exp_f32 v180, v180
    v_exp_f32 v181, v181
    v_exp_f32 v182, v182
    v_exp_f32 v183, v183
    v_cvt_pk_bf16_f32 v176, v176, v177
    v_cvt_pk_bf16_f32 v177, v178, v179
    v_mfma_f32_32x32x16_bf16 v[96:111], v[230:233], v[168:171], v[96:111]
    v_exp_f32 v184, v184
    v_exp_f32 v185, v185
    v_exp_f32 v186, v186
    v_exp_f32 v187, v187
    v_cvt_pk_bf16_f32 v178, v180, v181
    v_cvt_pk_bf16_f32 v179, v182, v183
    v_exp_f32 v188, v188
    v_exp_f32 v189, v189
    v_exp_f32 v190, v190
    v_exp_f32 v191, v191
    v_cvt_pk_bf16_f32 v184, v184, v185
    v_cvt_pk_bf16_f32 v185, v186, v187
    v_exp_f32 v128, v128
    v_exp_f32 v129, v129
    v_exp_f32 v130, v130
    v_exp_f32 v131, v131
    v_mfma_f32_32x32x16_bf16 v[112:127], v[226:229], v[176:179], v[112:127]
    v_cvt_pk_bf16_f32 v186, v188, v189
    v_cvt_pk_bf16_f32 v187, v190, v191
    v_exp_f32 v132, v132
    v_exp_f32 v133, v133
    v_mfma_f32_32x32x16_bf16 v[112:127], v[230:233], v[184:187], v[112:127]
    v_exp_f32 v134, v134
    v_exp_f32 v135, v135
    v_cvt_pk_bf16_f32 v128, v128, v129
    v_cvt_pk_bf16_f32 v129, v130, v131
    v_mfma_f32_32x32x16_bf16 v[176:191], v[234:237], v[20:23], 0
    v_exp_f32 v136, v136
    v_exp_f32 v137, v137
    v_exp_f32 v138, v138
    v_exp_f32 v139, v139
    v_mfma_f32_32x32x16_bf16 v[160:175], v[234:237], v[16:19], 0
    v_cvt_pk_bf16_f32 v130, v132, v133
    v_cvt_pk_bf16_f32 v131, v134, v135
    v_exp_f32 v140, v140
    v_exp_f32_e64 v141, v141
    s_waitcnt vmcnt(8)
    v_mfma_f32_32x32x16_bf16 v[64:79], v[240:243], v[128:131], v[64:79]
    v_exp_f32 v142, v142
    v_exp_f32 v143, v143
    v_cvt_pk_bf16_f32 v136, v136, v137
    v_cvt_pk_bf16_f32 v137, v138, v139
    v_exp_f32 v144, v144
    v_exp_f32 v145, v145
    v_mfma_f32_32x32x4_2b_bf16 v[160:191], v[238:239], v[26:27], v[160:191]
    v_exp_f32 v146, v146
    v_exp_f32 v147, v147
    v_cvt_pk_bf16_f32 v138, v140, v141
    v_cvt_pk_bf16_f32 v139, v142, v143
    v_exp_f32 v148, v148
    v_exp_f32 v149, v149
    v_exp_f32 v150, v150
    v_exp_f32 v151, v151
    v_cvt_pk_bf16_f32 v144, v144, v145
    v_cvt_pk_bf16_f32 v145, v146, v147
    v_mfma_f32_32x32x16_bf16 v[64:79], v[244:247], v[136:139], v[64:79]
    buffer_load_dwordx4 v[226:229], v61, s[44:47], s11 offen offset:1280
    buffer_load_dwordx4 v[230:233], v61, s[44:47], s11 offen offset:2048
    buffer_load_dwordx4 v[234:237], v62, s[44:47], s11 offen offset:3072
    buffer_load_dwordx2 v[238:239], v63, s[44:47], s11 offen offset:2816
    s_add_u32 s11, s11, 2816
    s_sub_u32 s13, s13, 1
    v_exp_f32 v152, v152
    v_exp_f32 v153, v153
    v_exp_f32 v154, v154
    v_exp_f32_e64 v155, v155
    v_cvt_pk_bf16_f32 v146, v148, v149
    v_cvt_pk_bf16_f32 v147, v150, v151
    v_exp_f32 v156, v156
    v_exp_f32 v157, v157
    v_exp_f32 v158, v158
    v_exp_f32 v159, v159
    v_cvt_pk_bf16_f32 v152, v152, v153
    v_cvt_pk_bf16_f32 v153, v154, v155
    v_exp_f32 v160, v160
    v_exp_f32 v161, v161
    v_exp_f32 v162, v162
    v_exp_f32 v163, v163
    v_mfma_f32_32x32x16_bf16 v[80:95], v[240:243], v[144:147], v[80:95]
    v_cvt_pk_bf16_f32 v154, v156, v157
    v_cvt_pk_bf16_f32 v155, v158, v159
    v_exp_f32 v164, v164
    v_exp_f32 v165, v165
    v_mfma_f32_32x32x16_bf16 v[80:95], v[244:247], v[152:155], v[80:95]
    v_exp_f32 v166, v166
    v_exp_f32 v167, v167
    v_cvt_pk_bf16_f32 v160, v160, v161
    v_cvt_pk_bf16_f32 v161, v162, v163
    v_mfma_f32_32x32x16_bf16 v[144:159], v[192:195], v[12:15], 0
    v_exp_f32 v168, v168
    v_exp_f32 v169, v169
    v_exp_f32 v170, v170
    v_exp_f32 v171, v171
    v_mfma_f32_32x32x16_bf16 v[128:143], v[192:195], v[8:11], 0
    v_cvt_pk_bf16_f32 v162, v164, v165
    v_cvt_pk_bf16_f32 v163, v166, v167
    v_exp_f32 v172, v172
    v_exp_f32 v173, v173
    v_mfma_f32_32x32x16_bf16 v[96:111], v[240:243], v[160:163], v[96:111]
    v_exp_f32 v174, v174
    v_exp_f32 v175, v175
    v_cvt_pk_bf16_f32 v168, v168, v169
    v_cvt_pk_bf16_f32 v169, v170, v171
    v_exp_f32 v176, v176
    v_exp_f32 v177, v177
    v_mfma_f32_32x32x4_2b_bf16 v[128:159], v[196:197], v[24:25], v[128:159]
    v_exp_f32 v178, v178
    v_exp_f32 v179, v179
    v_cvt_pk_bf16_f32 v170, v172, v173
    v_cvt_pk_bf16_f32 v171, v174, v175
    v_exp_f32 v180, v180
    v_exp_f32 v181, v181
    v_exp_f32_e64 v182, v182
    v_mov_b32_e64 v4, s13
    v_exp_f32_e64 v183, v183
    v_cvt_pk_bf16_f32 v176, v176, v177
    v_cvt_pk_bf16_f32 v177, v178, v179
    v_mfma_f32_32x32x16_bf16 v[96:111], v[244:247], v[168:171], v[96:111]
    ds_write_b32 v44, v4 offset:16
    ds_read_b32 v5, v44 offset:8
    s_cmp_lg_u32 s13, 0
    v_exp_f32 v184, v184
    v_exp_f32 v185, v185
    v_exp_f32 v186, v186
    v_exp_f32_e64 v187, v187
    v_cvt_pk_bf16_f32 v178, v180, v181
    v_cvt_pk_bf16_f32 v179, v182, v183
    v_exp_f32 v188, v188
    v_exp_f32 v189, v189
    v_exp_f32 v190, v190
    v_exp_f32 v191, v191
    v_cvt_pk_bf16_f32 v184, v184, v185
    v_cvt_pk_bf16_f32 v185, v186, v187
    s_cbranch_scc1 L_55
    v_mfma_f32_32x32x16_bf16 v[112:127], v[240:243], v[176:179], v[112:127]
    v_cvt_pk_bf16_f32 v186, v188, v189
    v_cvt_pk_bf16_f32 v187, v190, v191
    s_nop 1
    v_mfma_f32_32x32x16_bf16 v[112:127], v[244:247], v[184:187], v[112:127]
    s_mov_b32 s96, 131072
L_56:
    s_waitcnt lgkmcnt(0)
    v_readfirstlane_b32 s8, v5
    s_nop 0
    s_and_b32 s9, s8, 0xff
    s_cmp_eq_u32 s9, 4
    s_cbranch_scc1 L_57
    s_sleep 2
    ds_read_b32 v5, v44 offset:8
    s_sub_u32 s96, s96, 1
    s_cmp_lg_u32 s96, 0
    s_cbranch_scc1 L_56
L_57:
    s_bitcmp1_b32 s8, 8
    s_cbranch_scc1 L_53
L_54:
    ds_write_b128 v56, v[80:83] offset:0
    ds_write_b128 v56, v[84:87] offset:1024
    ds_write_b128 v56, v[88:91] offset:2048
    ds_write_b128 v56, v[96:99] offset:3072
    ds_write_b128 v56, v[100:103] offset:4096
    ds_write_b128 v56, v[104:107] offset:5120
    ds_write_b128 v56, v[112:115] offset:6144
    ds_write_b128 v56, v[116:119] offset:7168
    ds_write_b128 v56, v[120:123] offset:8192
    s_waitcnt lgkmcnt(0)
    s_barrier
    ds_read_b128 v[76:79], v57 offset:0
    ds_read_b128 v[80:83], v57 offset:1024
    ds_read_b128 v[84:87], v57 offset:2048
L_2:
    s_waitcnt lgkmcnt(0)
    v_readfirstlane_b32 s71, v5
    v_add_f32 v74, v74, v86
    v_add_f32 v72, v72, v84
    v_add_f32 v73, v73, v85
    v_add_f32 v64, v64, v76
    v_add_f32 v65, v65, v77
    v_add_f32 v66, v66, v78
    v_add_f32 v67, v67, v79
    v_add_f32 v68, v68, v80
    v_add_f32 v69, v69, v81
    v_add_f32 v70, v70, v82
    v_add_f32 v71, v71, v83
    v_rcp_f32 v74, v74
    s_nop 0
    v_mul_f32 v72, v72, v74
    v_mul_f32 v73, v73, v74
    v_mul_f32 v64, v64, v74
    v_mul_f32 v65, v65, v74
    v_mul_f32 v66, v66, v74
    v_mul_f32 v67, v67, v74
    v_mul_f32 v68, v68, v74
    v_mul_f32 v69, v69, v74
    v_mul_f32 v70, v70, v74
    v_mul_f32 v71, v71, v74
    v_cvt_pk_bf16_f32 v92, v72, v73
    v_cvt_pk_bf16_f32 v93, v72, v73
    v_cvt_pk_bf16_f32 v88, v64, v65
    v_cvt_pk_bf16_f32 v89, v66, v67
    v_cvt_pk_bf16_f32 v90, v68, v69
    v_cvt_pk_bf16_f32 v91, v70, v71
    v_permlane32_swap_b32 v92, v93
    s_waitcnt vmcnt(0)
    s_bitcmp1_b32 s71, 9
    s_cbranch_scc1 L_fast1
    buffer_store_dwordx4 v[88:91], v58, s[44:47], s72 offen sc1
    s_mov_b32 exec_hi, 0
    buffer_store_dwordx2 v[92:93], v59, s[44:47], s73 offen sc1
    s_branch L_fast2
L_fast1:
    buffer_store_dwordx4 v[88:91], v58, s[44:47], s72 offen nt
    s_mov_b32 exec_hi, 0
    buffer_store_dwordx2 v[92:93], v59, s[44:47], s73 offen nt
L_fast2:
    s_mov_b32 exec_hi, -1
    s_mov_b32 s56, s38
    s_mov_b32 s57, s39
    s_mov_b32 s58, 5242880
    s_mov_b32 s59, 0x20000
    s_lshl_b32 s12, s3, 1
    s_lshr_b32 s8, s77, 1
    s_add_u32 s12, s12, s8
    s_lshl_b32 s12, s12, 1
    s_add_u32 s12, s12, s76
    s_lshl_b32 s12, s12, 6
    s_add_u32 s12, s12, 16384
    v_lshl_add_u32 v4, v2, 2, s12
    s_lshl_b32 s8, s3, 8
    s_lshl_b32 s9, s4, 4
    s_add_u32 s8, s8, s9
    s_add_u32 s8, s8, 16384
    v_and_b32 v5, 3, v1
    v_lshl_add_u32 v5, v5, 2, s8
    v_bfe_u32 v6, v1, 2, 1
    v_lshl_add_u32 v5, v6, 7, v5
    s_mov_b32 s8, 0xffff0000
    s_mov_b32 s9, 0
    v_cndmask_b32 v4, v4, v5, s[8:9]
    v_lshlrev_b32 v5, 8, v3
    v_lshl_add_u32 v5, v2, 3, v5
    s_lshl_b32 s13, s3, 2
    s_add_u32 s13, s13, s77
    s_mul_i32 s13, s13, 20480
    s_add_u32 s13, s13, 262144
    s_lshl_b32 s8, s76, 11
    s_add_u32 s15, s13, s8
    s_add_u32 s15, s15, 16384
    s_lshl_b32 s8, s76, 13
    s_add_u32 s13, s13, s8
    s_add_u32 s10, s13, 4096
    v_mov_b32 v6, s78
    v_mov_b32 v7, 0
    s_cmp_lt_u32 s5, 4
    s_cbranch_scc1 L_58
    ds_read_b64_tr_b16 v[96:97], v52 offset:0
    ds_read_b64_tr_b16 v[98:99], v53 offset:0
    ds_read_b64_tr_b16 v[100:101], v52 offset:32
    ds_read_b64_tr_b16 v[102:103], v53 offset:32
    ds_read_b64_tr_b16 v[104:105], v52 offset:64
    ds_read_b64_tr_b16 v[106:107], v53 offset:64
    ds_read_b64_tr_b16 v[108:109], v52 offset:96
    ds_read_b64_tr_b16 v[110:111], v53 offset:96
    ds_read_b64_tr_b16 v[112:113], v52 offset:128
    ds_read_b64_tr_b16 v[114:115], v53 offset:128
    ds_read_b64_tr_b16 v[116:117], v52 offset:5120
    ds_read_b64_tr_b16 v[118:119], v53 offset:5120
    ds_read_b64_tr_b16 v[120:121], v52 offset:5152
    ds_read_b64_tr_b16 v[122:123], v53 offset:5152
    ds_read_b64_tr_b16 v[124:125], v52 offset:5184
    ds_read_b64_tr_b16 v[126:127], v53 offset:5184
    ds_read_b64_tr_b16 v[128:129], v52 offset:5216
    ds_read_b64_tr_b16 v[130:131], v53 offset:5216
    ds_read_b64_tr_b16 v[132:133], v52 offset:5248
    ds_read_b64_tr_b16 v[134:135], v53 offset:5248
L_58:
    s_waitcnt vmcnt(0)
    s_mov_b64 exec, 1
    s_bitcmp1_b32 s71, 9
    s_cbranch_scc1 L_fast3
    buffer_store_dword v6, v7, s[44:47], s74 offen sc1
    s_branch L_fast4
L_fast3:
    buffer_store_dword v6, v7, s[44:47], s74 offen
L_fast4:
    s_mov_b64 exec, -1
    s_cmp_lt_u32 s5, 4
    s_cbranch_scc1 L_59
    ds_read_b64_tr_b16 v[136:137], v52 offset:10240
    ds_read_b64_tr_b16 v[138:139], v53 offset:10240
    ds_read_b64_tr_b16 v[140:141], v52 offset:10272
    ds_read_b64_tr_b16 v[142:143], v53 offset:10272
    ds_read_b64_tr_b16 v[144:145], v52 offset:10304
    ds_read_b64_tr_b16 v[146:147], v53 offset:10304
    ds_read_b64_tr_b16 v[148:149], v52 offset:10336
    ds_read_b64_tr_b16 v[150:151], v53 offset:10336
    ds_read_b64_tr_b16 v[152:153], v52 offset:10368
    ds_read_b64_tr_b16 v[154:155], v53 offset:10368
    ds_read_b64_tr_b16 v[156:157], v52 offset:15360
    ds_read_b64_tr_b16 v[158:159], v53 offset:15360
    ds_read_b64_tr_b16 v[160:161], v52 offset:15392
    ds_read_b64_tr_b16 v[162:163], v53 offset:15392
    ds_read_b64_tr_b16 v[164:165], v52 offset:15424
    ds_read_b64_tr_b16 v[166:167], v53 offset:15424
    ds_read_b64_tr_b16 v[168:169], v52 offset:15456
    ds_read_b64_tr_b16 v[170:171], v53 offset:15456
    ds_read_b64_tr_b16 v[172:173], v52 offset:15488
    ds_read_b64_tr_b16 v[174:175], v53 offset:15488
    ds_read_b64_tr_b16 v[176:177], v52 offset:20480
    ds_read_b64_tr_b16 v[178:179], v53 offset:20480
    ds_read_b64_tr_b16 v[180:181], v52 offset:20512
    ds_read_b64_tr_b16 v[182:183], v53 offset:20512
    ds_read_b64_tr_b16 v[184:185], v52 offset:20544
    ds_read_b64_tr_b16 v[186:187], v53 offset:20544
    ds_read_b64_tr_b16 v[188:189], v52 offset:20576
    ds_read_b64_tr_b16 v[190:191], v53 offset:20576
    ds_read_b64_tr_b16 v[192:193], v52 offset:20608
    ds_read_b64_tr_b16 v[194:195], v53 offset:20608
    ds_read_b64_tr_b16 v[196:197], v52 offset:25600
    ds_read_b64_tr_b16 v[198:199], v53 offset:25600
    ds_read_b64_tr_b16 v[200:201], v52 offset:25632
    ds_read_b64_tr_b16 v[202:203], v53 offset:25632
    ds_read_b64_tr_b16 v[204:205], v52 offset:25664
    ds_read_b64_tr_b16 v[206:207], v53 offset:25664
    ds_read_b64_tr_b16 v[208:209], v52 offset:25696
    ds_read_b64_tr_b16 v[210:211], v53 offset:25696
    ds_read_b64_tr_b16 v[212:213], v52 offset:25728
    ds_read_b64_tr_b16 v[214:215], v53 offset:25728
    s_branch L_60
L_59:
    s_cmp_eq_u32 s70, 1
    s_cbranch_scc1 L_61
    s_lshl_b32 s11, s3, 7
    s_lshl_b32 s8, s5, 5
    s_add_u32 s11, s11, s8
    s_add_u32 s11, s11, 2883584
    s_mov_b32 s14, 12288
    s_mov_b32 exec_lo, -1
    s_mov_b32 exec_hi, 0xff
    s_mov_b32 s96, 131072
L_63:
    buffer_load_dwordx4 v[40:43], v50, s[44:47], s14 offen sc1
    s_waitcnt vmcnt(0)
    v_cmp_ne_u32 s[8:9], s78, v40
    v_cmp_ne_u32 vcc, s78, v41
    s_nop 0
    s_or_b64 s[8:9], s[8:9], vcc
    v_cmp_ne_u32 vcc, s78, v42
    s_nop 0
    s_or_b64 s[8:9], s[8:9], vcc
    v_cmp_ne_u32 vcc, s78, v43
    s_nop 0
    s_or_b64 s[8:9], s[8:9], vcc
    s_cmp_eq_u64 s[8:9], 0
    s_cbranch_scc1 L_64
    s_sleep 4
    s_sub_u32 s96, s96, 1
    s_cmp_lg_u32 s96, 0
    s_cbranch_scc1 L_63
L_64:
    buffer_load_dwordx4 v[24:27], v51, s[44:47], s11 offen sc1
    s_add_u32 s11, s11, 4096
    buffer_load_dwordx4 v[28:31], v51, s[44:47], s11 offen sc1
    s_add_u32 s11, s11, 4096
    buffer_load_dwordx4 v[32:35], v51, s[44:47], s11 offen sc1
    s_add_u32 s11, s11, 4096
    buffer_load_dwordx4 v[36:39], v51, s[44:47], s11 offen sc1
    s_mov_b32 s70, 1
    s_mov_b32 s14, 0xffff0000
    s_waitcnt vmcnt(0)
    v_lshlrev_b32 v64, 16, v8
    v_lshlrev_b32 v68, 16, v24
    v_and_b32 v65, s14, v8
    v_lshlrev_b32 v69, 16, v28
    v_lshlrev_b32 v66, 16, v9
    v_lshlrev_b32 v70, 16, v32
    v_and_b32 v67, s14, v9
    v_lshlrev_b32 v71, 16, v36
    v_mul_f32 v64, v64, v68
    v_mul_f32 v65, v65, v69
    v_mul_f32 v66, v66, v70
    v_mul_f32 v67, v67, v71
    v_cvt_pk_bf16_f32 v8, v64, v65
    v_cvt_pk_bf16_f32 v9, v66, v67
    s_mov_b32 s8, 0
    buffer_store_dwordx2 v[8:9], v49, s[56:59], s8 offen nt
    v_lshlrev_b32 v64, 16, v10
    v_and_b32 v68, s14, v24
    v_and_b32 v65, s14, v10
    v_and_b32 v69, s14, v28
    v_lshlrev_b32 v66, 16, v11
    v_and_b32 v70, s14, v32
    v_and_b32 v67, s14, v11
    v_and_b32 v71, s14, v36
    v_mul_f32 v64, v64, v68
    v_mul_f32 v65, v65, v69
    v_mul_f32 v66, v66, v70
    v_mul_f32 v67, v67, v71
    v_cvt_pk_bf16_f32 v10, v64, v65
    v_cvt_pk_bf16_f32 v11, v66, v67
    s_mov_b32 s8, 5120
    buffer_store_dwordx2 v[10:11], v49, s[56:59], s8 offen nt
    v_lshlrev_b32 v64, 16, v12
    v_lshlrev_b32 v68, 16, v25
    v_and_b32 v65, s14, v12
    v_lshlrev_b32 v69, 16, v29
    v_lshlrev_b32 v66, 16, v13
    v_lshlrev_b32 v70, 16, v33
    v_and_b32 v67, s14, v13
    v_lshlrev_b32 v71, 16, v37
    v_mul_f32 v64, v64, v68
    v_mul_f32 v65, v65, v69
    v_mul_f32 v66, v66, v70
    v_mul_f32 v67, v67, v71
    v_cvt_pk_bf16_f32 v12, v64, v65
    v_cvt_pk_bf16_f32 v13, v66, v67
    s_mov_b32 s8, 10240
    buffer_store_dwordx2 v[12:13], v49, s[56:59], s8 offen nt
    v_lshlrev_b32 v64, 16, v14
    v_and_b32 v68, s14, v25
    v_and_b32 v65, s14, v14
    v_and_b32 v69, s14, v29
    v_lshlrev_b32 v66, 16, v15
    v_and_b32 v70, s14, v33
    v_and_b32 v67, s14, v15
    v_and_b32 v71, s14, v37
    v_mul_f32 v64, v64, v68
    v_mul_f32 v65, v65, v69
    v_mul_f32 v66, v66, v70
    v_mul_f32 v67, v67, v71
    v_cvt_pk_bf16_f32 v14, v64, v65
    v_cvt_pk_bf16_f32 v15, v66, v67
    s_mov_b32 s8, 15360
    buffer_store_dwordx2 v[14:15], v49, s[56:59], s8 offen nt
    v_lshlrev_b32 v64, 16, v16
    v_lshlrev_b32 v68, 16, v26
    v_and_b32 v65, s14, v16
    v_lshlrev_b32 v69, 16, v30
    v_lshlrev_b32 v66, 16, v17
    v_lshlrev_b32 v70, 16, v34
    v_and_b32 v67, s14, v17
    v_lshlrev_b32 v71, 16, v38
    v_mul_f32 v64, v64, v68
    v_mul_f32 v65, v65, v69
    v_mul_f32 v66, v66, v70
    v_mul_f32 v67, v67, v71
    v_cvt_pk_bf16_f32 v16, v64, v65
    v_cvt_pk_bf16_f32 v17, v66, v67
    s_mov_b32 s8, 40960
    buffer_store_dwordx2 v[16:17], v49, s[56:59], s8 offen nt
    v_lshlrev_b32 v64, 16, v18
    v_and_b32 v68, s14, v26
    v_and_b32 v65, s14, v18
    v_and_b32 v69, s14, v30
    v_lshlrev_b32 v66, 16, v19
    v_and_b32 v70, s14, v34
    v_and_b32 v67, s14, v19
    v_and_b32 v71, s14, v38
    v_mul_f32 v64, v64, v68
    v_mul_f32 v65, v65, v69
    v_mul_f32 v66, v66, v70
    v_mul_f32 v67, v67, v71
    v_cvt_pk_bf16_f32 v18, v64, v65
    v_cvt_pk_bf16_f32 v19, v66, v67
    s_mov_b32 s8, 46080
    buffer_store_dwordx2 v[18:19], v49, s[56:59], s8 offen nt
    v_lshlrev_b32 v64, 16, v20
    v_lshlrev_b32 v68, 16, v27
    v_and_b32 v65, s14, v20
    v_lshlrev_b32 v69, 16, v31
    v_lshlrev_b32 v66, 16, v21
    v_lshlrev_b32 v70, 16, v35
    v_and_b32 v67, s14, v21
    v_lshlrev_b32 v71, 16, v39
    v_mul_f32 v64, v64, v68
    v_mul_f32 v65, v65, v69
    v_mul_f32 v66, v66, v70
    v_mul_f32 v67, v67, v71
    v_cvt_pk_bf16_f32 v20, v64, v65
    v_cvt_pk_bf16_f32 v21, v66, v67
    s_mov_b32 s8, 51200
    buffer_store_dwordx2 v[20:21], v49, s[56:59], s8 offen nt
    v_lshlrev_b32 v64, 16, v22
    v_and_b32 v68, s14, v27
    v_and_b32 v65, s14, v22
    v_and_b32 v69, s14, v31
    v_lshlrev_b32 v66, 16, v23
    v_and_b32 v70, s14, v35
    v_and_b32 v67, s14, v23
    v_and_b32 v71, s14, v39
    v_mul_f32 v64, v64, v68
    v_mul_f32 v65, v65, v69
    v_mul_f32 v66, v66, v70
    v_mul_f32 v67, v67, v71
    v_cvt_pk_bf16_f32 v22, v64, v65
    v_cvt_pk_bf16_f32 v23, v66, v67
    s_mov_b32 s8, 56320
    buffer_store_dwordx2 v[22:23], v49, s[56:59], s8 offen nt
L_62:
    s_mov_b64 exec, -1
L_61:
L_60:
    s_lshl_b32 s14, s64, 1
    s_add_u32 s14, s14, s65
    s_add_u32 s14, s14, 1280
    s_mov_b32 s96, 131072
L_65:
    buffer_load_dword v6, v4, s[44:47], 0 offen sc1
    s_waitcnt vmcnt(0)
    v_cmp_ne_u32 s[8:9], s78, v6
    s_nop 0
    s_cmp_eq_u64 s[8:9], 0
    s_cbranch_scc1 L_66
    s_sleep 1
    s_sub_u32 s96, s96, 1
    s_cmp_lg_u32 s96, 0
    s_cbranch_scc1 L_65
L_66:
    buffer_load_dwordx4 v[8:11], v62, s[44:47], s13 offen offset:0 sc1
    buffer_load_dwordx4 v[12:15], v62, s[44:47], s13 offen offset:1024 sc1
    buffer_load_dwordx4 v[16:19], v62, s[44:47], s13 offen offset:2048 sc1
    buffer_load_dwordx4 v[20:23], v62, s[44:47], s13 offen offset:3072 sc1
    buffer_load_dwordx2 v[24:25], v5, s[44:47], s15 offen offset:0 sc1
    buffer_load_dwordx2 v[26:27], v5, s[44:47], s15 offen offset:128 sc1
    buffer_load_dwordx4 v[28:31], v62, s[44:47], s10 offen offset:0 sc1
    buffer_load_dwordx4 v[32:35], v62, s[44:47], s10 offen offset:1024 sc1
    buffer_load_dwordx4 v[36:39], v62, s[44:47], s10 offen offset:2048 sc1
    buffer_load_dwordx4 v[40:43], v62, s[44:47], s10 offen offset:3072 sc1
    buffer_load_dwordx2 v[44:45], v5, s[44:47], s15 offen offset:1024 sc1
    buffer_load_dwordx2 v[46:47], v5, s[44:47], s15 offen offset:1152 sc1
    s_cmp_lt_u32 s5, 4
    s_cbranch_scc1 L_67
    ds_read_b64_tr_b16 v[216:217], v52 offset:30720
    ds_read_b64_tr_b16 v[218:219], v53 offset:30720
    ds_read_b64_tr_b16 v[220:221], v52 offset:30752
    ds_read_b64_tr_b16 v[222:223], v53 offset:30752
    ds_read_b64_tr_b16 v[224:225], v52 offset:30784
    ds_read_b64_tr_b16 v[226:227], v53 offset:30784
    ds_read_b64_tr_b16 v[228:229], v52 offset:30816
    ds_read_b64_tr_b16 v[230:231], v53 offset:30816
    ds_read_b64_tr_b16 v[232:233], v52 offset:30848
    ds_read_b64_tr_b16 v[234:235], v53 offset:30848
    ds_read_b64_tr_b16 v[236:237], v52 offset:35840
    ds_read_b64_tr_b16 v[238:239], v53 offset:35840
    ds_read_b64_tr_b16 v[240:241], v52 offset:35872
    ds_read_b64_tr_b16 v[242:243], v53 offset:35872
    ds_read_b64_tr_b16 v[244:245], v52 offset:35904
    ds_read_b64_tr_b16 v[246:247], v53 offset:35904
    ds_read_b64_tr_b16 v[248:249], v52 offset:35936
    ds_read_b64_tr_b16 v[250:251], v53 offset:35936
    ds_read_b64_tr_b16 v[252:253], v52 offset:35968
    ds_read_b64_tr_b16 v[254:255], v53 offset:35968
    v_add_u32 v84, 0, v0
    v_mul_u32_u24 v85, 6554, v84
    v_lshrrev_b32 v85, 16, v85
    v_mul_u32_u24 v86, 10, v85
    v_sub_u32 v86, v84, v86
    v_mul_u32_u24 v94, 336, v85
    v_lshl_add_u32 v94, v86, 5, v94
    v_add_u32 v94, 102400, v94
    v_mul_u32_u24 v60, 2560, v85
    v_lshl_add_u32 v60, v86, 4, v60
L_67:
    s_waitcnt vmcnt(11) lgkmcnt(15)
    v_mfma_f32_16x16x32_bf16 v[64:67], v[96:99], v[8:11], 0
    v_mfma_f32_16x16x32_bf16 v[68:71], v[100:103], v[8:11], 0
    v_mfma_f32_16x16x32_bf16 v[72:75], v[104:107], v[8:11], 0
    v_mfma_f32_16x16x32_bf16 v[76:79], v[108:111], v[8:11], 0
    v_mfma_f32_16x16x32_bf16 v[80:83], v[112:115], v[8:11], 0
    ds_read_b64_tr_b16 v[96:97], v52 offset:40960
    ds_read_b64_tr_b16 v[98:99], v53 offset:40960
    ds_read_b64_tr_b16 v[100:101], v52 offset:40992
    ds_read_b64_tr_b16 v[102:103], v53 offset:40992
    ds_read_b64_tr_b16 v[104:105], v52 offset:41024
    ds_read_b64_tr_b16 v[106:107], v53 offset:41024
    ds_read_b64_tr_b16 v[108:109], v52 offset:41056
    ds_read_b64_tr_b16 v[110:111], v53 offset:41056
    ds_read_b64_tr_b16 v[112:113], v52 offset:41088
    ds_read_b64_tr_b16 v[114:115], v53 offset:41088
    s_waitcnt vmcnt(10)
    v_mfma_f32_16x16x32_bf16 v[64:67], v[116:119], v[12:15], v[64:67]
    v_mfma_f32_16x16x32_bf16 v[68:71], v[120:123], v[12:15], v[68:71]
    v_mfma_f32_16x16x32_bf16 v[72:75], v[124:127], v[12:15], v[72:75]
    v_mfma_f32_16x16x32_bf16 v[76:79], v[128:131], v[12:15], v[76:79]
    v_mfma_f32_16x16x32_bf16 v[80:83], v[132:135], v[12:15], v[80:83]
    ds_read_b64_tr_b16 v[116:117], v52 offset:46080
    ds_read_b64_tr_b16 v[118:119], v53 offset:46080
    ds_read_b64_tr_b16 v[120:121], v52 offset:46112
    ds_read_b64_tr_b16 v[122:123], v53 offset:46112
    ds_read_b64_tr_b16 v[124:125], v52 offset:46144
    ds_read_b64_tr_b16 v[126:127], v53 offset:46144
    ds_read_b64_tr_b16 v[128:129], v52 offset:46176
    ds_read_b64_tr_b16 v[130:131], v53 offset:46176
    ds_read_b64_tr_b16 v[132:133], v52 offset:46208
    ds_read_b64_tr_b16 v[134:135], v53 offset:46208
    s_waitcnt vmcnt(9)
    v_mfma_f32_16x16x32_bf16 v[64:67], v[136:139], v[16:19], v[64:67]
    v_mfma_f32_16x16x32_bf16 v[68:71], v[140:143], v[16:19], v[68:71]
    v_mfma_f32_16x16x32_bf16 v[72:75], v[144:147], v[16:19], v[72:75]
    v_mfma_f32_16x16x32_bf16 v[76:79], v[148:151], v[16:19], v[76:79]
    v_mfma_f32_16x16x32_bf16 v[80:83], v[152:155], v[16:19], v[80:83]
    s_waitcnt vmcnt(8)
    v_mfma_f32_16x16x32_bf16 v[64:67], v[156:159], v[20:23], v[64:67]
    v_mfma_f32_16x16x32_bf16 v[68:71], v[160:163], v[20:23], v[68:71]
    v_mfma_f32_16x16x32_bf16 v[72:75], v[164:167], v[20:23], v[72:75]
    v_mfma_f32_16x16x32_bf16 v[76:79], v[168:171], v[20:23], v[76:79]
    v_mfma_f32_16x16x32_bf16 v[80:83], v[172:175], v[20:23], v[80:83]
    s_waitcnt vmcnt(6)
    v_mfma_f32_16x16x32_bf16 v[64:67], v[176:179], v[24:27], v[64:67]
    v_mfma_f32_16x16x32_bf16 v[68:71], v[180:183], v[24:27], v[68:71]
    v_mfma_f32_16x16x32_bf16 v[72:75], v[184:187], v[24:27], v[72:75]
    v_mfma_f32_16x16x32_bf16 v[76:79], v[188:191], v[24:27], v[76:79]
    v_mfma_f32_16x16x32_bf16 v[80:83], v[192:195], v[24:27], v[80:83]
    s_waitcnt vmcnt(5)
    v_mfma_f32_16x16x32_bf16 v[64:67], v[196:199], v[28:31], v[64:67]
    v_mfma_f32_16x16x32_bf16 v[68:71], v[200:203], v[28:31], v[68:71]
    v_mfma_f32_16x16x32_bf16 v[72:75], v[204:207], v[28:31], v[72:75]
    v_mfma_f32_16x16x32_bf16 v[76:79], v[208:211], v[28:31], v[76:79]
    v_mfma_f32_16x16x32_bf16 v[80:83], v[212:215], v[28:31], v[80:83]
    s_waitcnt vmcnt(4) lgkmcnt(15)
    v_mfma_f32_16x16x32_bf16 v[64:67], v[216:219], v[32:35], v[64:67]
    v_mfma_f32_16x16x32_bf16 v[68:71], v[220:223], v[32:35], v[68:71]
    v_mfma_f32_16x16x32_bf16 v[72:75], v[224:227], v[32:35], v[72:75]
    v_mfma_f32_16x16x32_bf16 v[76:79], v[228:231], v[32:35], v[76:79]
    v_mfma_f32_16x16x32_bf16 v[80:83], v[232:235], v[32:35], v[80:83]
    s_waitcnt vmcnt(3)
    v_mfma_f32_16x16x32_bf16 v[64:67], v[236:239], v[36:39], v[64:67]
    v_mfma_f32_16x16x32_bf16 v[68:71], v[240:243], v[36:39], v[68:71]
    v_mfma_f32_16x16x32_bf16 v[72:75], v[244:247], v[36:39], v[72:75]
    v_mfma_f32_16x16x32_bf16 v[76:79], v[248:251], v[36:39], v[76:79]
    v_mfma_f32_16x16x32_bf16 v[80:83], v[252:255], v[36:39], v[80:83]
    s_waitcnt vmcnt(2) lgkmcnt(10)
    v_mfma_f32_16x16x32_bf16 v[64:67], v[96:99], v[40:43], v[64:67]
    v_mfma_f32_16x16x32_bf16 v[68:71], v[100:103], v[40:43], v[68:71]
    v_mfma_f32_16x16x32_bf16 v[72:75], v[104:107], v[40:43], v[72:75]
    v_mfma_f32_16x16x32_bf16 v[76:79], v[108:111], v[40:43], v[76:79]
    v_mfma_f32_16x16x32_bf16 v[80:83], v[112:115], v[40:43], v[80:83]
    s_waitcnt vmcnt(0) lgkmcnt(0)
    v_mfma_f32_16x16x32_bf16 v[64:67], v[116:119], v[44:47], v[64:67]
    v_mfma_f32_16x16x32_bf16 v[68:71], v[120:123], v[44:47], v[68:71]
    v_mfma_f32_16x16x32_bf16 v[72:75], v[124:127], v[44:47], v[72:75]
    v_mfma_f32_16x16x32_bf16 v[76:79], v[128:131], v[44:47], v[76:79]
    v_mfma_f32_16x16x32_bf16 v[80:83], v[132:135], v[44:47], v[80:83]
    s_nop 3
    ds_write_b128 v54, v[64:67] offset:0
    ds_write_b128 v54, v[68:71] offset:64
    ds_write_b128 v54, v[72:75] offset:128
    ds_write_b128 v54, v[76:79] offset:192
    ds_write_b128 v54, v[80:83] offset:256
    s_waitcnt lgkmcnt(0)
    s_barrier
    ds_read_b128 v[96:99], v94
    ds_read_b128 v[100:103], v94 offset:16
    ds_read_b128 v[104:107], v94 offset:21504
    ds_read_b128 v[108:111], v94 offset:21520
    s_cmp_ge_u32 s5, 2
    s_cbranch_scc1 L_68
    ds_read_b128 v[112:115], v95
    ds_read_b128 v[116:119], v95 offset:16
    ds_read_b128 v[120:123], v95 offset:21504
    ds_read_b128 v[124:127], v95 offset:21520
    s_waitcnt lgkmcnt(0)
    v_add_f32 v112, v112, v120
    v_add_f32 v113, v113, v121
    v_add_f32 v114, v114, v122
    v_add_f32 v115, v115, v123
    v_add_f32 v116, v116, v124
    v_add_f32 v117, v117, v125
    v_add_f32 v118, v118, v126
    v_add_f32 v119, v119, v127
    v_cvt_pk_bf16_f32 v120, v112, v113
    v_cvt_pk_bf16_f32 v121, v114, v115
    v_cvt_pk_bf16_f32 v122, v116, v117
    v_cvt_pk_bf16_f32 v123, v118, v119
    buffer_store_dwordx4 v[120:123], v55, s[56:59], s14 offen nt
L_68:
    s_waitcnt lgkmcnt(0)
    v_add_f32 v96, v96, v104
    v_add_f32 v97, v97, v105
    v_add_f32 v98, v98, v106
    v_add_f32 v99, v99, v107
    v_add_f32 v100, v100, v108
    v_add_f32 v101, v101, v109
    v_add_f32 v102, v102, v110
    v_add_f32 v103, v103, v111
    v_cvt_pk_bf16_f32 v104, v96, v97
    v_cvt_pk_bf16_f32 v105, v98, v99
    v_cvt_pk_bf16_f32 v106, v100, v101
    v_cvt_pk_bf16_f32 v107, v102, v103
    buffer_store_dwordx4 v[104:107], v60, s[56:59], s14 offen nt
L_fin:
L_exit:
    s_endpgm
L_53:
    s_waitcnt vmcnt(0)
    s_nop 15
    s_nop 3
    v_mov_b32 v36, 0xff800000
    v_mov_b32 v37, 0xff800000
    v_mov_b32 v38, 0xff800000
    v_mov_b32 v39, 0xff800000
    s_mov_b32 s11, 32768
    s_mov_b32 s14, 64
    s_mov_b32 s13, 16
L_69:
    buffer_load_dwordx4 v[28:31], v62, s[44:47], s11 offen offset:256 sc1
    buffer_load_dwordx2 v[32:33], v63, s[44:47], s11 offen offset:0 sc1
    s_waitcnt vmcnt(0)
    v_mfma_f32_32x32x16_bf16 v[128:143], v[28:31], v[8:11], 0
    v_mfma_f32_32x32x16_bf16 v[144:159], v[28:31], v[12:15], 0
    v_mfma_f32_32x32x16_bf16 v[160:175], v[28:31], v[16:19], 0
    v_mfma_f32_32x32x16_bf16 v[176:191], v[28:31], v[20:23], 0
    s_nop 7
    v_mfma_f32_32x32x4_2b_bf16 v[128:159], v[32:33], v[24:25], v[128:159]
    s_nop 0
    v_mfma_f32_32x32x4_2b_bf16 v[160:191], v[32:33], v[26:27], v[160:191]
    s_nop 15
    s_nop 1
    v_max3_f32 v36, v36, v128, v129
    v_max3_f32 v36, v36, v130, v131
    v_max3_f32 v36, v36, v132, v133
    v_max3_f32 v36, v36, v134, v135
    v_max3_f32 v36, v36, v136, v137
    v_max3_f32 v36, v36, v138, v139
    v_max3_f32 v36, v36, v140, v141
    v_max3_f32 v36, v36, v142, v143
    v_max3_f32 v37, v37, v144, v145
    v_max3_f32 v37, v37, v146, v147
    v_max3_f32 v37, v37, v148, v149
    v_max3_f32 v37, v37, v150, v151
    v_max3_f32 v37, v37, v152, v153
    v_max3_f32 v37, v37, v154, v155
    v_max3_f32 v37, v37, v156, v157
    v_max3_f32 v37, v37, v158, v159
    v_max3_f32 v38, v38, v160, v161
    v_max3_f32 v38, v38, v162, v163
    v_max3_f32 v38, v38, v164, v165
    v_max3_f32 v38, v38, v166, v167
    v_max3_f32 v38, v38, v168, v169
    v_max3_f32 v38, v38, v170, v171
    v_max3_f32 v38, v38, v172, v173
    v_max3_f32 v38, v38, v174, v175
    v_max3_f32 v39, v39, v176, v177
    v_max3_f32 v39, v39, v178, v179
    v_max3_f32 v39, v39, v180, v181
    v_max3_f32 v39, v39, v182, v183
    v_max3_f32 v39, v39, v184, v185
    v_max3_f32 v39, v39, v186, v187
    v_max3_f32 v39, v39, v188, v189
    v_max3_f32 v39, v39, v190, v191
    s_add_u32 s11, s11, 2816
    s_sub_u32 s14, s14, 1
    s_cmp_lg_u32 s14, 0
    s_cbranch_scc1 L_69
    v_mov_b32 v40, v36
    s_nop 1
    v_permlane32_swap_b32 v36, v40
    v_max_f32 v40, v40, v36
    v_sub_f32 v192, 0, v40
    v_sub_f32 v193, 0, v40
    v_sub_f32 v194, 0, v40
    v_sub_f32 v195, 0, v40
    v_sub_f32 v196, 0, v40
    v_sub_f32 v197, 0, v40
    v_sub_f32 v198, 0, v40
    v_sub_f32 v199, 0, v40
    v_sub_f32 v200, 0, v40
    v_sub_f32 v201, 0, v40
    v_sub_f32 v202, 0, v40
    v_sub_f32 v203, 0, v40
    v_sub_f32 v204, 0, v40
    v_sub_f32 v205, 0, v40
    v_sub_f32 v206, 0, v40
    v_sub_f32 v207, 0, v40
    v_mov_b32 v40, v37
    s_nop 1
    v_permlane32_swap_b32 v37, v40
    v_max_f32 v40, v40, v37
    v_sub_f32 v208, 0, v40
    v_sub_f32 v209, 0, v40
    v_sub_f32 v210, 0, v40
    v_sub_f32 v211, 0, v40
    v_sub_f32 v212, 0, v40
    v_sub_f32 v213, 0, v40
    v_sub_f32 v214, 0, v40
    v_sub_f32 v215, 0, v40
    v_sub_f32 v216, 0, v40
    v_sub_f32 v217, 0, v40
    v_sub_f32 v218, 0, v40
    v_sub_f32 v219, 0, v40
    v_sub_f32 v220, 0, v40
    v_sub_f32 v221, 0, v40
    v_sub_f32 v222, 0, v40
    v_sub_f32 v223, 0, v40
    v_mov_b32 v40, v38
    s_nop 1
    v_permlane32_swap_b32 v38, v40
    v_max_f32 v40, v40, v38
    v_sub_f32 v224, 0, v40
    v_sub_f32 v225, 0, v40
    v_sub_f32 v226, 0, v40
    v_sub_f32 v227, 0, v40
    v_sub_f32 v228, 0, v40
    v_sub_f32 v229, 0, v40
    v_sub_f32 v230, 0, v40
    v_sub_f32 v231, 0, v40
    v_sub_f32 v232, 0, v40
    v_sub_f32 v233, 0, v40
    v_sub_f32 v234, 0, v40
    v_sub_f32 v235, 0, v40
    v_sub_f32 v236, 0, v40
    v_sub_f32 v237, 0, v40
    v_sub_f32 v238, 0, v40
    v_sub_f32 v239, 0, v40
    v_mov_b32 v40, v39
    s_nop 1
    v_permlane32_swap_b32 v39, v40
    v_max_f32 v40, v40, v39
    v_sub_f32 v240, 0, v40
    v_sub_f32 v241, 0, v40
    v_sub_f32 v242, 0, v40
    v_sub_f32 v243, 0, v40
    v_sub_f32 v244, 0, v40
    v_sub_f32 v245, 0, v40
    v_sub_f32 v246, 0, v40
    v_sub_f32 v247, 0, v40
    v_sub_f32 v248, 0, v40
    v_sub_f32 v249, 0, v40
    v_sub_f32 v250, 0, v40
    v_sub_f32 v251, 0, v40
    v_sub_f32 v252, 0, v40
    v_sub_f32 v253, 0, v40
    v_sub_f32 v254, 0, v40
    v_sub_f32 v255, 0, v40
    v_mov_b32 v6, v52
    v_mov_b32 v7, v53
    v_mov_b32 v52, 0
    v_mov_b32 v53, 0
    v_mov_b32 v54, 0
    v_mov_b32 v55, 0
    s_nop 1
    v_mfma_f32_32x32x16_bf16 v[64:79], v[52:55], v[52:55], 0
    v_mfma_f32_32x32x16_bf16 v[80:95], v[52:55], v[52:55], 0
    v_mfma_f32_32x32x16_bf16 v[96:111], v[52:55], v[52:55], 0
    v_mfma_f32_32x32x16_bf16 v[112:127], v[52:55], v[52:55], 0
    s_mov_b32 s11, s79
    buffer_load_dwordx4 v[28:31], v62, s[44:47], s11 offen offset:256 sc1
    buffer_load_dwordx2 v[32:33], v63, s[44:47], s11 offen offset:0 sc1
    buffer_load_dwordx4 v[34:37], v61, s[44:47], s11 offen offset:1280 sc1
    buffer_load_dwordx4 v[38:41], v61, s[44:47], s11 offen offset:2048 sc1
    buffer_load_dwordx4 v[42:45], v62, s[44:47], s11 offen offset:3072 sc1
    buffer_load_dwordx2 v[46:47], v63, s[44:47], s11 offen offset:2816 sc1
    s_add_u32 s11, s11, 2816
    s_waitcnt vmcnt(4) lgkmcnt(0)
    v_mfma_f32_32x32x16_bf16 v[128:143], v[28:31], v[8:11], v[192:207]
    v_mfma_f32_32x32x16_bf16 v[144:159], v[28:31], v[12:15], v[208:223]
    v_mov_b32 v184, 0
    v_mov_b32 v185, 0
    v_mov_b32 v186, 0
    v_mov_b32 v187, 0
    v_mov_b32 v188, 0
    v_mov_b32 v189, 0
    v_mov_b32 v190, 0
    v_mov_b32 v191, 0
    v_mov_b32 v176, 0
    v_mov_b32 v48, 0
    v_mov_b32 v177, 0
    v_mov_b32 v49, 0
    v_mov_b32 v178, 0
    v_mov_b32 v50, 0
    v_mov_b32 v179, 0
    v_mov_b32 v51, 0
    v_mfma_f32_32x32x4_2b_bf16 v[128:159], v[32:33], v[24:25], v[128:159]
    s_nop 15
    s_nop 3
    .p2align 6
L_70:
    v_exp_f32 v128, v128
    v_exp_f32 v129, v129
    v_exp_f32 v130, v130
    v_exp_f32 v131, v131
    v_mfma_f32_32x32x16_bf16 v[112:127], v[48:51], v[176:179], v[112:127]
    v_cvt_pk_bf16_f32 v186, v188, v189
    v_cvt_pk_bf16_f32 v187, v190, v191
    v_exp_f32 v132, v132
    v_exp_f32 v133, v133
    v_mfma_f32_32x32x16_bf16 v[112:127], v[52:55], v[184:187], v[112:127]
    v_exp_f32 v134, v134
    v_exp_f32 v135, v135
    v_cvt_pk_bf16_f32 v128, v128, v129
    v_cvt_pk_bf16_f32 v129, v130, v131
    v_mfma_f32_32x32x16_bf16 v[176:191], v[28:31], v[20:23], v[240:255]
    v_exp_f32 v136, v136
    v_exp_f32 v137, v137
    v_exp_f32 v138, v138
    v_exp_f32 v139, v139
    v_mfma_f32_32x32x16_bf16 v[160:175], v[28:31], v[16:19], v[224:239]
    v_cvt_pk_bf16_f32 v130, v132, v133
    v_cvt_pk_bf16_f32 v131, v134, v135
    v_exp_f32 v140, v140
    v_exp_f32_e64 v141, v141
    s_waitcnt vmcnt(0)
    v_mfma_f32_32x32x16_bf16 v[64:79], v[34:37], v[128:131], v[64:79]
    v_exp_f32 v142, v142
    v_exp_f32 v143, v143
    v_cvt_pk_bf16_f32 v136, v136, v137
    v_cvt_pk_bf16_f32 v137, v138, v139
    v_exp_f32 v144, v144
    v_exp_f32 v145, v145
    v_mfma_f32_32x32x4_2b_bf16 v[160:191], v[32:33], v[26:27], v[160:191]
    v_exp_f32 v146, v146
    v_exp_f32 v147, v147
    v_cvt_pk_bf16_f32 v138, v140, v141
    v_cvt_pk_bf16_f32 v139, v142, v143
    v_exp_f32 v148, v148
    v_exp_f32 v149, v149
    v_exp_f32 v150, v150
    v_exp_f32 v151, v151
    v_cvt_pk_bf16_f32 v144, v144, v145
    v_cvt_pk_bf16_f32 v145, v146, v147
    v_mfma_f32_32x32x16_bf16 v[64:79], v[38:41], v[136:139], v[64:79]
    buffer_load_dwordx4 v[48:51], v61, s[44:47], s11 offen offset:1280
    buffer_load_dwordx4 v[52:55], v61, s[44:47], s11 offen offset:2048
    buffer_load_dwordx4 v[28:31], v62, s[44:47], s11 offen offset:3072
    buffer_load_dwordx2 v[32:33], v63, s[44:47], s11 offen offset:2816
    s_add_u32 s11, s11, 2816
    v_exp_f32 v152, v152
    v_exp_f32 v153, v153
    v_exp_f32 v154, v154
    v_exp_f32 v155, v155
    v_cvt_pk_bf16_f32 v146, v148, v149
    v_cvt_pk_bf16_f32 v147, v150, v151
    v_exp_f32 v156, v156
    v_exp_f32 v157, v157
    v_exp_f32 v158, v158
    v_exp_f32 v159, v159
    v_cvt_pk_bf16_f32 v152, v152, v153
    v_cvt_pk_bf16_f32 v153, v154, v155
    v_exp_f32 v160, v160
    v_exp_f32 v161, v161
    v_exp_f32 v162, v162
    v_exp_f32 v163, v163
    v_mfma_f32_32x32x16_bf16 v[80:95], v[34:37], v[144:147], v[80:95]
    v_cvt_pk_bf16_f32 v154, v156, v157
    v_cvt_pk_bf16_f32 v155, v158, v159
    v_exp_f32 v164, v164
    v_exp_f32 v165, v165
    v_mfma_f32_32x32x16_bf16 v[80:95], v[38:41], v[152:155], v[80:95]
    v_exp_f32 v166, v166
    v_exp_f32 v167, v167
    v_cvt_pk_bf16_f32 v160, v160, v161
    v_cvt_pk_bf16_f32 v161, v162, v163
    v_mfma_f32_32x32x16_bf16 v[144:159], v[42:45], v[12:15], v[208:223]
    v_exp_f32 v168, v168
    v_exp_f32 v169, v169
    v_exp_f32 v170, v170
    v_exp_f32 v171, v171
    v_mfma_f32_32x32x16_bf16 v[128:143], v[42:45], v[8:11], v[192:207]
    v_cvt_pk_bf16_f32 v162, v164, v165
    v_cvt_pk_bf16_f32 v163, v166, v167
    v_exp_f32 v172, v172
    v_exp_f32 v173, v173
    v_mfma_f32_32x32x16_bf16 v[96:111], v[34:37], v[160:163], v[96:111]
    v_exp_f32 v174, v174
    v_exp_f32 v175, v175
    v_cvt_pk_bf16_f32 v168, v168, v169
    v_cvt_pk_bf16_f32 v169, v170, v171
    v_exp_f32 v176, v176
    v_exp_f32 v177, v177
    v_mfma_f32_32x32x4_2b_bf16 v[128:159], v[46:47], v[24:25], v[128:159]
    v_exp_f32 v178, v178
    v_exp_f32 v179, v179
    v_cvt_pk_bf16_f32 v170, v172, v173
    v_cvt_pk_bf16_f32 v171, v174, v175
    v_exp_f32 v180, v180
    v_exp_f32 v181, v181
    v_exp_f32 v182, v182
    v_exp_f32 v183, v183
    v_cvt_pk_bf16_f32 v176, v176, v177
    v_cvt_pk_bf16_f32 v177, v178, v179
    v_mfma_f32_32x32x16_bf16 v[96:111], v[38:41], v[168:171], v[96:111]
    v_exp_f32 v184, v184
    v_exp_f32 v185, v185
    v_exp_f32 v186, v186
    v_exp_f32 v187, v187
    v_cvt_pk_bf16_f32 v178, v180, v181
    v_cvt_pk_bf16_f32 v179, v182, v183
    v_exp_f32 v188, v188
    v_exp_f32 v189, v189
    v_exp_f32 v190, v190
    v_exp_f32 v191, v191
    v_cvt_pk_bf16_f32 v184, v184, v185
    v_cvt_pk_bf16_f32 v185, v186, v187
    v_exp_f32 v128, v128
    v_exp_f32 v129, v129
    v_exp_f32 v130, v130
    v_exp_f32 v131, v131
    v_mfma_f32_32x32x16_bf16 v[112:127], v[34:37], v[176:179], v[112:127]
    v_cvt_pk_bf16_f32 v186, v188, v189
    v_cvt_pk_bf16_f32 v187, v190, v191
    v_exp_f32 v132, v132
    v_exp_f32 v133, v133
    v_mfma_f32_32x32x16_bf16 v[112:127], v[38:41], v[184:187], v[112:127]
    v_exp_f32 v134, v134
    v_exp_f32 v135, v135
    v_cvt_pk_bf16_f32 v128, v128, v129
    v_cvt_pk_bf16_f32 v129, v130, v131
    v_mfma_f32_32x32x16_bf16 v[176:191], v[42:45], v[20:23], v[240:255]
    v_exp_f32 v136, v136
    v_exp_f32 v137, v137
    v_exp_f32 v138, v138
    v_exp_f32 v139, v139
    v_mfma_f32_32x32x16_bf16 v[160:175], v[42:45], v[16:19], v[224:239]
    v_cvt_pk_bf16_f32 v130, v132, v133
    v_cvt_pk_bf16_f32 v131, v134, v135
    v_exp_f32 v140, v140
    v_exp_f32_e64 v141, v141
    s_waitcnt vmcnt(0)
    v_mfma_f32_32x32x16_bf16 v[64:79], v[48:51], v[128:131], v[64:79]
    v_exp_f32 v142, v142
    v_exp_f32 v143, v143
    v_cvt_pk_bf16_f32 v136, v136, v137
    v_cvt_pk_bf16_f32 v137, v138, v139
    v_exp_f32 v144, v144
    v_exp_f32 v145, v145
    v_mfma_f32_32x32x4_2b_bf16 v[160:191], v[46:47], v[26:27], v[160:191]
    v_exp_f32 v146, v146
    v_exp_f32 v147, v147
    v_cvt_pk_bf16_f32 v138, v140, v141
    v_cvt_pk_bf16_f32 v139, v142, v143
    v_exp_f32 v148, v148
    v_exp_f32 v149, v149
    v_exp_f32 v150, v150
    v_exp_f32 v151, v151
    v_cvt_pk_bf16_f32 v144, v144, v145
    v_cvt_pk_bf16_f32 v145, v146, v147
    v_mfma_f32_32x32x16_bf16 v[64:79], v[52:55], v[136:139], v[64:79]
    buffer_load_dwordx4 v[34:37], v61, s[44:47], s11 offen offset:1280
    buffer_load_dwordx4 v[38:41], v61, s[44:47], s11 offen offset:2048
    buffer_load_dwordx4 v[42:45], v62, s[44:47], s11 offen offset:3072
    buffer_load_dwordx2 v[46:47], v63, s[44:47], s11 offen offset:2816
    s_add_u32 s11, s11, 2816
    s_sub_u32 s13, s13, 1
    v_exp_f32 v152, v152
    v_exp_f32 v153, v153
    v_exp_f32 v154, v154
    v_exp_f32_e64 v155, v155
    v_cvt_pk_bf16_f32 v146, v148, v149
    v_cvt_pk_bf16_f32 v147, v150, v151
    v_exp_f32 v156, v156
    v_exp_f32 v157, v157
    v_exp_f32 v158, v158
    v_exp_f32 v159, v159
    v_cvt_pk_bf16_f32 v152, v152, v153
    v_cvt_pk_bf16_f32 v153, v154, v155
    v_exp_f32 v160, v160
    v_exp_f32 v161, v161
    v_exp_f32 v162, v162
    v_exp_f32 v163, v163
    v_mfma_f32_32x32x16_bf16 v[80:95], v[48:51], v[144:147], v[80:95]
    v_cvt_pk_bf16_f32 v154, v156, v157
    v_cvt_pk_bf16_f32 v155, v158, v159
    v_exp_f32 v164, v164
    v_exp_f32 v165, v165
    v_mfma_f32_32x32x16_bf16 v[80:95], v[52:55], v[152:155], v[80:95]
    v_exp_f32 v166, v166
    v_exp_f32 v167, v167
    v_cvt_pk_bf16_f32 v160, v160, v161
    v_cvt_pk_bf16_f32 v161, v162, v163
    v_mfma_f32_32x32x16_bf16 v[144:159], v[28:31], v[12:15], v[208:223]
    v_exp_f32 v168, v168
    v_exp_f32 v169, v169
    v_exp_f32 v170, v170
    v_exp_f32 v171, v171
    v_mfma_f32_32x32x16_bf16 v[128:143], v[28:31], v[8:11], v[192:207]
    v_cvt_pk_bf16_f32 v162, v164, v165
    v_cvt_pk_bf16_f32 v163, v166, v167
    v_exp_f32 v172, v172
    v_exp_f32 v173, v173
    v_mfma_f32_32x32x16_bf16 v[96:111], v[48:51], v[160:163], v[96:111]
    v_exp_f32 v174, v174
    v_exp_f32 v175, v175
    v_cvt_pk_bf16_f32 v168, v168, v169
    v_cvt_pk_bf16_f32 v169, v170, v171
    v_exp_f32 v176, v176
    v_exp_f32 v177, v177
    v_mfma_f32_32x32x4_2b_bf16 v[128:159], v[32:33], v[24:25], v[128:159]
    v_exp_f32 v178, v178
    v_exp_f32 v179, v179
    v_cvt_pk_bf16_f32 v170, v172, v173
    v_cvt_pk_bf16_f32 v171, v174, v175
    v_exp_f32 v180, v180
    v_exp_f32 v181, v181
    v_exp_f32 v182, v182
    v_exp_f32 v183, v183
    v_cvt_pk_bf16_f32 v176, v176, v177
    v_cvt_pk_bf16_f32 v177, v178, v179
    v_mfma_f32_32x32x16_bf16 v[96:111], v[52:55], v[168:171], v[96:111]
    s_cmp_lg_u32 s13, 0
    v_exp_f32 v184, v184
    v_exp_f32 v185, v185
    v_exp_f32 v186, v186
    v_exp_f32_e64 v187, v187
    v_cvt_pk_bf16_f32 v178, v180, v181
    v_cvt_pk_bf16_f32 v179, v182, v183
    v_exp_f32 v188, v188
    v_exp_f32 v189, v189
    v_exp_f32 v190, v190
    v_exp_f32 v191, v191
    v_cvt_pk_bf16_f32 v184, v184, v185
    v_cvt_pk_bf16_f32 v185, v186, v187
    s_cbranch_scc1 L_70
    v_mfma_f32_32x32x16_bf16 v[112:127], v[48:51], v[176:179], v[112:127]
    v_cvt_pk_bf16_f32 v186, v188, v189
    v_cvt_pk_bf16_f32 v187, v190, v191
    s_nop 1
    v_mfma_f32_32x32x16_bf16 v[112:127], v[52:55], v[184:187], v[112:127]
    s_waitcnt vmcnt(0)
    v_mov_b32 v52, v6
    v_mov_b32 v53, v7
    v_mul_u32_u24 v54, 336, v2
    v_lshl_add_u32 v54, v3, 4, v54
    s_mul_i32 s8, s77, 5376
    s_mul_i32 s9, s76, 21504
    s_add_u32 s8, s8, s9
    s_add_u32 s8, s8, 102400
    v_add_u32 v54, s8, v54
    s_nop 7
    s_nop 7
    s_branch L_54
.section .rodata,"a"
.p2align 6
.amdhsa_kernel concat_heads__ssm_conv_h3__grouped_kv_mqa__prompt_kernel
  .amdhsa_next_free_vgpr 256
  .amdhsa_next_free_sgpr 100
  .amdhsa_accum_offset 256
  .amdhsa_group_segment_fixed_size 0
  .amdhsa_kernarg_size 112
  .amdhsa_user_sgpr_count 2
  .amdhsa_user_sgpr_kernarg_segment_ptr 1
  .amdhsa_system_sgpr_workgroup_id_x 1
.end_amdhsa_kernel
```
